```python
import torch

def _softmax(x, axis=-1):
    return torch.softmax(x, dim=axis)

def _gelu(x):
    return torch.nn.functional.gelu(x, approximate='tanh')

def _silu(x):
    return torch.nn.functional.silu(x)

def _sigmoid(x):
    return torch.sigmoid(x)

def _layernorm(x, axis=-1, eps=1e-05):
    m = x.mean(dim=axis, keepdim=True)
    v = x.var(dim=axis, keepdim=True, unbiased=False)
    return (x - m) / torch.sqrt(v + eps)

def _scatter_add(tgt, idx, src, axis=0):
    return tgt.clone().index_add_(axis, idx, src)

def _segment_sum(src, seg, n):
    out = torch.zeros((n,) + src.shape[1:], dtype=src.dtype)
    return out.index_add_(0, seg, src)

def _pad(x, pw):
    flat = tuple((v for pair in reversed(pw) for v in pair))
    return torch.nn.functional.pad(x, flat)
kernel_name = 'adaLN_cond__gqa_block_cached__swiglu_ffn__decode'

def setup_inputs():

    _w = lambda a: (lambda t: t.to(torch.bfloat16) if t.is_floating_point() else t)(torch.as_tensor(a))

    def _A_setup():
        B, Sq, D = (1, 1, 512)
        Hq, Hkv, Sk, Dh = (32, 8, 32768, 128)
        assert Hq % Hkv == 0, (Hq, Hkv)
        return {'x': _w((lambda *s: torch.randn(*s, dtype=torch.bfloat16) * 0.1)(B, Sq, D)), 'k_cache': _w((lambda *s: torch.randn(*s, dtype=torch.bfloat16) * 0.8)(B, Hkv, Sk, Dh)), 'v_cache': _w((lambda *s: torch.randn(*s, dtype=torch.bfloat16) * 0.8)(B, Hkv, Sk, Dh)), 'wq': _w((lambda *s: torch.randn(*s, dtype=torch.bfloat16) * 0.8)(D, Hq * Dh) * D ** (-0.5)), 'wo': _w((lambda *s: torch.randn(*s, dtype=torch.bfloat16) * 0.8)(Hq * Dh, D) * (Hq * Dh) ** (-0.5))}
    _A_in = _A_setup()

    def _B_setup():
        B, S, D, F = (1, 1, 512, 1792)
        return {'x': _w((lambda *s: torch.randn(*s, dtype=torch.bfloat16) * 0.1)(B, S, D)), 'w_gate': _w((lambda *s: torch.randn(*s, dtype=torch.bfloat16) * 0.1)(D, F)), 'w_up': _w((lambda *s: torch.randn(*s, dtype=torch.bfloat16) * 0.1)(D, F)), 'w_down': _w((lambda *s: torch.randn(*s, dtype=torch.bfloat16) * 0.1)(F, D))}
    _B_in = _B_setup()
    return {'A_x': _A_in['x'], 'A_k_cache': _A_in['k_cache'], 'A_v_cache': _A_in['v_cache'], 'A_wq': _A_in['wq'], 'A_wo': _A_in['wo'], 'B_x': _B_in['x'], 'B_w_gate': _B_in['w_gate'], 'B_w_up': _B_in['w_up'], 'B_w_down': _B_in['w_down'], 'c': _w((lambda *s: torch.randn(*s, dtype=torch.bfloat16) * 0.4)(1, 512) * 8.0), 'w_mod': _w((lambda *s: torch.randn(*s, dtype=torch.bfloat16) * 0.4)(512, 6 * 512) * 512 ** (-0.5) * 8.0)}

def reference(A_x, A_k_cache, A_v_cache, A_wq, A_wo, B_x, B_w_gate, B_w_up, B_w_down, c, w_mod):

    def _A_ref(x, k_cache, v_cache, wq, wo):
        B, Sq, D = x.shape
        Hq, Dh = (32, 128)
        Hkv = k_cache.shape[1]
        rep = Hq // Hkv
        q = (lambda x, *d: x.permute(*d))((x @ wq).reshape(B, Sq, Hq, Dh), 0, 2, 1, 3)
        k = (lambda x, n, axis: torch.repeat_interleave(x, n, dim=axis))(k_cache, rep, axis=1)
        v = (lambda x, n, axis: torch.repeat_interleave(x, n, dim=axis))(v_cache, rep, axis=1)
        scores = torch.einsum('bhqd,bhkd->bhqk', q, k) * Dh ** (-0.5)
        p = _softmax(scores, axis=-1)
        o = torch.einsum('bhqk,bhkd->bhqd', p, v)
        return (lambda x, *d: x.permute(*d))(o, 0, 2, 1, 3).reshape(B, Sq, Hq * Dh) @ wo

    def _B_ref(x, w_gate, w_up, w_down):
        g = _silu(x @ w_gate)
        u = x @ w_up
        return g * u @ w_down
    x = A_x
    mod = (_silu(c) @ w_mod).reshape(c.shape[0], 6, 1, -1)
    sa, ca, ga, sb, cb, gb = (mod[:, 0].clone(), mod[:, 1].clone(), mod[:, 2].clone(), mod[:, 3].clone(), mod[:, 4].clone(), mod[:, 5].clone())
    h = _layernorm(x, axis=-1) * (1 + ca) + sa
    x = x + ga * _A_ref(h, A_k_cache, A_v_cache, A_wq, A_wo)
    h = _layernorm(x, axis=-1) * (1 + cb) + sb
    x = x + gb * _B_ref(h, B_w_gate, B_w_up, B_w_down)
    return x
```

```asm
; @launch grid=(256,1,1) block=(512,1,1) lds=160000
.amdgcn_target "amdgcn-amd-amdhsa--gfx950"
.text
.globl adaLN_cond__gqa_block_cached__swiglu_ffn__decode_kernel
.p2align 8
.type adaLN_cond__gqa_block_cached__swiglu_ffn__decode_kernel,@function
adaLN_cond__gqa_block_cached__swiglu_ffn__decode_kernel:
L_entry:
    s_getpc_b64 s[76:77]
L_pc:
    s_load_dwordx16 s[8:23], s[0:1], 0
    s_load_dwordx4 s[32:35], s[0:1], 96
    s_load_dwordx8 s[24:31], s[0:1], 64
    s_cmp_ge_u32 s2, 256
    s_cbranch_scc1 L_exit
    s_mov_b32 s78, L_code_end-L_pc
    s_mov_b32 s79, 0x20000
    v_lshlrev_b32 v3, 4, v0
    s_cmp_ge_u32 s2, 16
    s_cbranch_scc1 L_nopf0
    s_and_b32 s80, s2, 7
    s_cmp_eq_u32 s80, 0
    s_cselect_b32 s80, L_service-L_pc, 0
    buffer_load_dwordx4 v[248:251], v3, s[76:79], s80 offen
    s_cbranch_scc0 L_nopf0
    s_add_u32 s80, s80, 0x2000
    buffer_load_dwordx4 v[252:255], v3, s[76:79], s80 offen
L_nopf0:
    v_lshrrev_b32 v2, 6, v0
    v_and_b32 v1, 63, v0
    s_and_b32 s80, s2, 7
    s_lshr_b32 s81, s2, 3
    v_readfirstlane_b32 s3, v2
    s_cmp_lg_u32 s80, 0
    s_cbranch_scc1 L_attention
    v_mov_b32 v4, 0
    v_mov_b32 v5, 0x200000
    s_waitcnt lgkmcnt(0)
    global_load_dword v240, v4, s[14:15]
    global_load_dword v241, v4, s[28:29]
    global_load_dword v242, v5, s[14:15]
    global_load_dword v243, v5, s[28:29]
    global_load_dword v244, v4, s[8:9]
    global_load_dword v245, v4, s[26:27]
    global_load_dword v246, v4, s[34:35]
    s_branch L_service
L_attention:
    s_cmp_gt_u32 s80, 0
    s_cselect_b32 s82, 1, 0
    s_sub_u32 s82, s80, s82
    s_lshl_b32 s82, s82, 5
    s_add_u32 s82, s82, s81
    s_mov_b32 s83, 153391690
    s_mul_hi_u32 s84, s82, s83
    s_mul_i32 s85, s84, 28
    s_sub_u32 s85, s82, s85
    s_lshl_b32 s86, s85, 3
    s_add_u32 s86, s86, s3
    s_lshl_b32 s87, s86, 8
    s_mov_b32 s83, 613566757
    s_mul_hi_u32 s88, s87, s83
    s_add_u32 s87, s87, 256
    s_mul_hi_u32 s89, s87, s83
    s_sub_u32 s89, s89, s88
    s_lshl_b32 s52, s88, 10
    s_lshl_b32 s90, s84, 23
    v_bfe_u32 v2, v1, 2, 2
    v_lshlrev_b32 v2, 8, v2
    v_lshrrev_b32 v6, 4, v1
    v_lshlrev_b32 v6, 6, v6
    v_and_b32 v7, 3, v1
    v_lshlrev_b32 v3, 4, v7
    v_add3_u32 v2, v2, v6, v3
    s_waitcnt lgkmcnt(0)
    s_load_dword s100, s[34:35], 65536
    s_add_u32 s36, s10, s90
    s_addc_u32 s37, s11, 0
    s_mov_b32 s38, 8388608
    s_mov_b32 s39, 0x20000
    s_mov_b32 s53, s52
    buffer_load_dwordx4 v[108:111], v2, s[36:39], s53 offen offset:0 nt
    buffer_load_dwordx4 v[112:115], v2, s[36:39], s53 offen offset:1024 nt
    buffer_load_dwordx4 v[116:119], v2, s[36:39], s53 offen offset:2048 nt
    buffer_load_dwordx4 v[120:123], v2, s[36:39], s53 offen offset:3072 nt
    v_mov_b32 v12, 16768
    v_mov_b32 v13, 0
    ds_write_b32 v12, v13
    s_waitcnt lgkmcnt(0)
    s_barrier
    s_add_u32 s40, s12, s90
    s_addc_u32 s41, s13, 0
    s_mov_b32 s42, 8388608
    s_mov_b32 s43, 0x20000
    s_mov_b32 s44, s34
    s_mov_b32 s45, s35
    s_mov_b32 s46, 2097152
    s_mov_b32 s47, 0x20000
    s_add_u32 s54, s52, 36864
    s_cmp_eq_u32 s89, 37
    s_cselect_b32 s54, s54, 268435456
    s_cselect_b32 s56, 0, 0xff800000
    s_lshl_b32 s55, s84, 11
    s_add_u32 s55, s55, 16384
    s_mov_b32 s57, 0x3e0293ee
    s_mul_i32 s58, s84, 28
    s_add_u32 s58, s58, s85
    s_lshl_b32 s59, s58, 7
    s_add_u32 s59, s59, 122880
    s_lshl_b32 s58, s58, 11
    s_add_u32 s58, s58, 151552
    s_mov_b32 s94, 0x05040100
    s_mov_b32 s95, 0x07060302
    s_mov_b32 s99, 100000
    v_lshlrev_b32 v4, 9, v7
    v_lshl_add_u32 v4, v6, 1, v4
    v_bfe_u32 v6, v1, 2, 2
    v_lshl_add_u32 v4, v6, 5, v4
    v_lshlrev_b32 v3, 4, v1
    v_mov_b32 v21, 0xff800000
    s_mul_i32 s48, s3, 16384
    s_add_u32 s48, s48, 16896
    s_getreg_b32 s51, hwreg(HW_REG_XCC_ID)
    s_bitcmp1_b32 s51, 0
    s_cselect_b64 vcc, 0, -1
    s_waitcnt vmcnt(3)
    s_addk_i32 s53, 0x1000
    buffer_load_dwordx4 v[124:127], v2, s[36:39], s53 offen offset:0 nt
    s_waitcnt vmcnt(3)
    buffer_load_dwordx4 v[128:131], v2, s[36:39], s53 offen offset:1024 nt
    s_waitcnt vmcnt(3)
    buffer_load_dwordx4 v[132:135], v2, s[36:39], s53 offen offset:2048 nt
    s_waitcnt vmcnt(3)
    buffer_load_dwordx4 v[136:139], v2, s[36:39], s53 offen offset:3072 nt
    s_waitcnt vmcnt(3)
    s_addk_i32 s53, 0x1000
    buffer_load_dwordx4 v[140:143], v2, s[36:39], s53 offen offset:0 nt
    s_waitcnt vmcnt(3)
    buffer_load_dwordx4 v[144:147], v2, s[36:39], s53 offen offset:1024 nt
    s_waitcnt vmcnt(3)
    buffer_load_dwordx4 v[148:151], v2, s[36:39], s53 offen offset:2048 nt
    s_waitcnt vmcnt(3)
    buffer_load_dwordx4 v[152:155], v2, s[36:39], s53 offen offset:3072 nt
    s_waitcnt vmcnt(3)
    s_addk_i32 s53, 0x1000
    buffer_load_dwordx4 v[156:159], v2, s[36:39], s53 offen offset:0 nt
    s_waitcnt vmcnt(3)
    buffer_load_dwordx4 v[160:163], v2, s[36:39], s53 offen offset:1024 nt
    s_waitcnt vmcnt(3)
    buffer_load_dwordx4 v[164:167], v2, s[36:39], s53 offen offset:2048 nt
    s_waitcnt vmcnt(3)
    buffer_load_dwordx4 v[168:171], v2, s[36:39], s53 offen offset:3072 nt
    s_waitcnt vmcnt(3)
    s_addk_i32 s53, 0x1000
    buffer_load_dwordx4 v[172:175], v2, s[36:39], s53 offen offset:0 nt
    s_waitcnt vmcnt(3)
    buffer_load_dwordx4 v[176:179], v2, s[36:39], s53 offen offset:1024 nt
    s_waitcnt vmcnt(3)
    buffer_load_dwordx4 v[180:183], v2, s[36:39], s53 offen offset:2048 nt
    s_waitcnt vmcnt(3)
    buffer_load_dwordx4 v[184:187], v2, s[36:39], s53 offen offset:3072 nt
    s_waitcnt vmcnt(3)
    s_addk_i32 s53, 0x1000
    buffer_load_dwordx4 v[188:191], v2, s[36:39], s53 offen offset:0 nt
    s_waitcnt vmcnt(3)
    buffer_load_dwordx4 v[192:195], v2, s[36:39], s53 offen offset:1024 nt
    s_waitcnt vmcnt(3)
    buffer_load_dwordx4 v[196:199], v2, s[36:39], s53 offen offset:2048 nt
    s_waitcnt vmcnt(3)
    buffer_load_dwordx4 v[200:203], v2, s[36:39], s53 offen offset:3072 nt
    s_waitcnt vmcnt(3)
    s_addk_i32 s53, 0x1000
    buffer_load_dwordx4 v[204:207], v2, s[36:39], s53 offen offset:0 nt
    s_waitcnt vmcnt(3)
    buffer_load_dwordx4 v[208:211], v2, s[36:39], s53 offen offset:1024 nt
    s_waitcnt vmcnt(3)
    buffer_load_dwordx4 v[212:215], v2, s[36:39], s53 offen offset:2048 nt
    s_waitcnt vmcnt(3)
    buffer_load_dwordx4 v[216:219], v2, s[36:39], s53 offen offset:3072 nt
    s_waitcnt vmcnt(3)
    s_addk_i32 s53, 0x1000
    buffer_load_dwordx4 v[220:223], v2, s[36:39], s53 offen offset:0 nt
    s_waitcnt vmcnt(3)
    buffer_load_dwordx4 v[224:227], v2, s[36:39], s53 offen offset:1024 nt
    s_waitcnt vmcnt(3)
    buffer_load_dwordx4 v[228:231], v2, s[36:39], s53 offen offset:2048 nt
    s_waitcnt vmcnt(3)
    buffer_load_dwordx4 v[232:235], v2, s[36:39], s53 offen offset:3072 nt
    s_waitcnt vmcnt(3)
    s_addk_i32 s53, 0x1000
    buffer_load_dwordx4 v[236:239], v2, s[36:39], s53 offen offset:0 nt
    s_waitcnt vmcnt(3)
    buffer_load_dwordx4 v[240:243], v2, s[36:39], s53 offen offset:1024 nt
    s_waitcnt vmcnt(3)
    buffer_load_dwordx4 v[244:247], v2, s[36:39], s53 offen offset:2048 nt
    s_waitcnt vmcnt(3)
    buffer_load_dwordx4 v[248:251], v2, s[36:39], s53 offen offset:3072 nt
    s_waitcnt vmcnt(3)
    buffer_load_dwordx4 v[252:255], v2, s[36:39], s54 offen nt
    s_waitcnt vmcnt(3)
    s_add_u32 s49, s52, 0
    s_add_u32 s50, s48, 0
    s_mov_b32 m0, s50
    s_nop 0
    buffer_load_dwordx4 v3, s[40:43], s49 offen offset:0 nt lds
    s_waitcnt vmcnt(3)
    buffer_load_dwordx4 v3, s[40:43], s49 offen offset:1024 nt lds
    s_waitcnt vmcnt(3)
    buffer_load_dwordx4 v3, s[40:43], s49 offen offset:2048 nt lds
    s_waitcnt vmcnt(3)
    buffer_load_dwordx4 v3, s[40:43], s49 offen offset:3072 nt lds
    s_waitcnt vmcnt(3)
    s_add_u32 s49, s52, 4096
    s_add_u32 s50, s48, 4096
    s_mov_b32 m0, s50
    s_nop 0
    buffer_load_dwordx4 v3, s[40:43], s49 offen offset:0 nt lds
    s_waitcnt vmcnt(3)
    buffer_load_dwordx4 v3, s[40:43], s49 offen offset:1024 nt lds
    s_waitcnt vmcnt(3)
    buffer_load_dwordx4 v3, s[40:43], s49 offen offset:2048 nt lds
    s_waitcnt vmcnt(3)
    buffer_load_dwordx4 v3, s[40:43], s49 offen offset:3072 nt lds
    s_waitcnt vmcnt(3)
    buffer_load_dwordx4 v[24:27], v4, s[44:47], s55 offen offset:0 sc1
    buffer_load_dwordx4 v[28:31], v4, s[44:47], s55 offen offset:16 sc1
    s_waitcnt vmcnt(3)
    s_add_u32 s49, s52, 8192
    s_add_u32 s50, s48, 8192
    s_mov_b32 m0, s50
    s_nop 0
    buffer_load_dwordx4 v3, s[40:43], s49 offen offset:0 nt lds
    s_waitcnt vmcnt(3)
    buffer_load_dwordx4 v3, s[40:43], s49 offen offset:1024 nt lds
    s_waitcnt vmcnt(3)
    buffer_load_dwordx4 v3, s[40:43], s49 offen offset:2048 nt lds
    s_waitcnt vmcnt(3)
    buffer_load_dwordx4 v3, s[40:43], s49 offen offset:3072 nt lds
    s_waitcnt vmcnt(3)
    s_add_u32 s49, s52, 12288
    s_add_u32 s50, s48, 12288
    s_mov_b32 m0, s50
    s_nop 0
    buffer_load_dwordx4 v3, s[40:43], s49 offen offset:0 nt lds
    s_waitcnt vmcnt(3)
    buffer_load_dwordx4 v3, s[40:43], s49 offen offset:1024 nt lds
    s_waitcnt vmcnt(3)
    buffer_load_dwordx4 v3, s[40:43], s49 offen offset:2048 nt lds
    s_waitcnt vmcnt(3)
    buffer_load_dwordx4 v3, s[40:43], s49 offen offset:3072 nt lds
    s_waitcnt lgkmcnt(0)
    s_and_b32 s100, s100, 0x7f
    s_add_u32 s100, s100, 1
    v_msad_u8 v6, v24, s100, 0
    v_msad_u8 v6, v28, s100, v6
    v_cmp_ne_u32 vcc, 0, v6
    s_cbranch_vccz L_qok_1
L_qspin_2:
    s_sleep 8
    buffer_load_dwordx4 v[24:27], v4, s[44:47], s55 offen offset:0 sc1
    buffer_load_dwordx4 v[28:31], v4, s[44:47], s55 offen offset:16 sc1
    s_waitcnt vmcnt(0)
    v_msad_u8 v6, v24, s100, 0
    v_msad_u8 v6, v28, s100, v6
    v_cmp_ne_u32 vcc, 0, v6
    s_cbranch_vccz L_qok_1
    s_sub_u32 s99, s99, 1
    s_cmp_gt_i32 s99, 0
    s_cbranch_scc1 L_qspin_2
L_qok_1:
    v_cvt_pk_bf16_f32 v8, v24, v25
    v_cvt_pk_bf16_f32 v9, v26, v27
    v_cvt_pk_bf16_f32 v10, v28, v29
    v_cvt_pk_bf16_f32 v11, v30, v31
    s_getreg_b32 s51, hwreg(HW_REG_XCC_ID)
    s_bitcmp1_b32 s51, 0
    s_cselect_b64 vcc, 0, -1
    v_lshl_add_u32 v5, v1, 4, s48
    v_mfma_f32_16x16x32_bf16 v[24:27], v[172:175], v[8:11], 0
    v_mfma_f32_16x16x32_bf16 v[28:31], v[176:179], v[8:11], 0
    v_mfma_f32_16x16x32_bf16 v[32:35], v[180:183], v[8:11], 0
    v_mfma_f32_16x16x32_bf16 v[36:39], v[184:187], v[8:11], 0
    s_add_u32 s53, s52, 16384
    buffer_load_dwordx4 v[172:175], v3, s[40:43], s53 offen offset:0 nt
    buffer_load_dwordx4 v[176:179], v3, s[40:43], s53 offen offset:1024 nt
    buffer_load_dwordx4 v[180:183], v3, s[40:43], s53 offen offset:2048 nt
    buffer_load_dwordx4 v[184:187], v3, s[40:43], s53 offen offset:3072 nt
    v_mfma_f32_16x16x32_bf16 v[40:43], v[188:191], v[8:11], 0
    v_mfma_f32_16x16x32_bf16 v[44:47], v[192:195], v[8:11], 0
    v_mfma_f32_16x16x32_bf16 v[48:51], v[196:199], v[8:11], 0
    v_mfma_f32_16x16x32_bf16 v[52:55], v[200:203], v[8:11], 0
    v_mov_b32_dpp v16, v24 quad_perm:[0,1,2,3] row_mask:0xf bank_mask:0x1
    v_add_f32_dpp v16, v25, v16 row_ror:12 row_mask:0xf bank_mask:0x1
    v_add_f32_dpp v16, v26, v16 row_ror:8 row_mask:0xf bank_mask:0x1
    v_add_f32_dpp v16, v27, v16 row_ror:4 row_mask:0xf bank_mask:0x1
    v_mov_b32_dpp v16, v28 row_ror:4 row_mask:0xf bank_mask:0x2
    v_add_f32_dpp v16, v29, v16 quad_perm:[0,1,2,3] row_mask:0xf bank_mask:0x2
    v_add_f32_dpp v16, v30, v16 row_ror:12 row_mask:0xf bank_mask:0x2
    v_add_f32_dpp v16, v31, v16 row_ror:8 row_mask:0xf bank_mask:0x2
    v_mov_b32_dpp v16, v32 row_ror:8 row_mask:0xf bank_mask:0x4
    v_add_f32_dpp v16, v33, v16 row_ror:4 row_mask:0xf bank_mask:0x4
    v_add_f32_dpp v16, v34, v16 quad_perm:[0,1,2,3] row_mask:0xf bank_mask:0x4
    v_add_f32_dpp v16, v35, v16 row_ror:12 row_mask:0xf bank_mask:0x4
    v_mov_b32_dpp v16, v36 row_ror:12 row_mask:0xf bank_mask:0x8
    v_add_f32_dpp v16, v37, v16 row_ror:8 row_mask:0xf bank_mask:0x8
    v_add_f32_dpp v16, v38, v16 row_ror:4 row_mask:0xf bank_mask:0x8
    v_add_f32_dpp v16, v39, v16 quad_perm:[0,1,2,3] row_mask:0xf bank_mask:0x8
    v_mfma_f32_16x16x32_bf16 v[24:27], v[204:207], v[8:11], 0
    v_mfma_f32_16x16x32_bf16 v[28:31], v[208:211], v[8:11], 0
    v_mfma_f32_16x16x32_bf16 v[32:35], v[212:215], v[8:11], 0
    v_mfma_f32_16x16x32_bf16 v[36:39], v[216:219], v[8:11], 0
    v_mov_b32_dpp v17, v40 quad_perm:[0,1,2,3] row_mask:0xf bank_mask:0x1
    v_add_f32_dpp v17, v41, v17 row_ror:12 row_mask:0xf bank_mask:0x1
    v_add_f32_dpp v17, v42, v17 row_ror:8 row_mask:0xf bank_mask:0x1
    v_add_f32_dpp v17, v43, v17 row_ror:4 row_mask:0xf bank_mask:0x1
    v_mov_b32_dpp v17, v44 row_ror:4 row_mask:0xf bank_mask:0x2
    v_add_f32_dpp v17, v45, v17 quad_perm:[0,1,2,3] row_mask:0xf bank_mask:0x2
    v_add_f32_dpp v17, v46, v17 row_ror:12 row_mask:0xf bank_mask:0x2
    v_add_f32_dpp v17, v47, v17 row_ror:8 row_mask:0xf bank_mask:0x2
    v_mov_b32_dpp v17, v48 row_ror:8 row_mask:0xf bank_mask:0x4
    v_add_f32_dpp v17, v49, v17 row_ror:4 row_mask:0xf bank_mask:0x4
    v_add_f32_dpp v17, v50, v17 quad_perm:[0,1,2,3] row_mask:0xf bank_mask:0x4
    v_add_f32_dpp v17, v51, v17 row_ror:12 row_mask:0xf bank_mask:0x4
    v_mov_b32_dpp v17, v52 row_ror:12 row_mask:0xf bank_mask:0x8
    v_add_f32_dpp v17, v53, v17 row_ror:8 row_mask:0xf bank_mask:0x8
    v_add_f32_dpp v17, v54, v17 row_ror:4 row_mask:0xf bank_mask:0x8
    v_add_f32_dpp v17, v55, v17 quad_perm:[0,1,2,3] row_mask:0xf bank_mask:0x8
    v_mfma_f32_16x16x32_bf16 v[40:43], v[220:223], v[8:11], 0
    v_mfma_f32_16x16x32_bf16 v[44:47], v[224:227], v[8:11], 0
    v_mfma_f32_16x16x32_bf16 v[48:51], v[228:231], v[8:11], 0
    v_mfma_f32_16x16x32_bf16 v[52:55], v[232:235], v[8:11], 0
    v_mov_b32_dpp v18, v24 quad_perm:[0,1,2,3] row_mask:0xf bank_mask:0x1
    v_add_f32_dpp v18, v25, v18 row_ror:12 row_mask:0xf bank_mask:0x1
    v_add_f32_dpp v18, v26, v18 row_ror:8 row_mask:0xf bank_mask:0x1
    v_add_f32_dpp v18, v27, v18 row_ror:4 row_mask:0xf bank_mask:0x1
    v_mov_b32_dpp v18, v28 row_ror:4 row_mask:0xf bank_mask:0x2
    v_add_f32_dpp v18, v29, v18 quad_perm:[0,1,2,3] row_mask:0xf bank_mask:0x2
    v_add_f32_dpp v18, v30, v18 row_ror:12 row_mask:0xf bank_mask:0x2
    v_add_f32_dpp v18, v31, v18 row_ror:8 row_mask:0xf bank_mask:0x2
    v_mov_b32_dpp v18, v32 row_ror:8 row_mask:0xf bank_mask:0x4
    v_add_f32_dpp v18, v33, v18 row_ror:4 row_mask:0xf bank_mask:0x4
    v_add_f32_dpp v18, v34, v18 quad_perm:[0,1,2,3] row_mask:0xf bank_mask:0x4
    v_add_f32_dpp v18, v35, v18 row_ror:12 row_mask:0xf bank_mask:0x4
    v_mov_b32_dpp v18, v36 row_ror:12 row_mask:0xf bank_mask:0x8
    v_add_f32_dpp v18, v37, v18 row_ror:8 row_mask:0xf bank_mask:0x8
    v_add_f32_dpp v18, v38, v18 row_ror:4 row_mask:0xf bank_mask:0x8
    v_add_f32_dpp v18, v39, v18 quad_perm:[0,1,2,3] row_mask:0xf bank_mask:0x8
    v_mfma_f32_16x16x32_bf16 v[24:27], v[236:239], v[8:11], 0
    v_mfma_f32_16x16x32_bf16 v[28:31], v[240:243], v[8:11], 0
    v_mfma_f32_16x16x32_bf16 v[32:35], v[244:247], v[8:11], 0
    v_mfma_f32_16x16x32_bf16 v[36:39], v[248:251], v[8:11], 0
    v_mov_b32_dpp v19, v40 quad_perm:[0,1,2,3] row_mask:0xf bank_mask:0x1
    v_add_f32_dpp v19, v41, v19 row_ror:12 row_mask:0xf bank_mask:0x1
    v_add_f32_dpp v19, v42, v19 row_ror:8 row_mask:0xf bank_mask:0x1
    v_add_f32_dpp v19, v43, v19 row_ror:4 row_mask:0xf bank_mask:0x1
    v_mov_b32_dpp v19, v44 row_ror:4 row_mask:0xf bank_mask:0x2
    v_add_f32_dpp v19, v45, v19 quad_perm:[0,1,2,3] row_mask:0xf bank_mask:0x2
    v_add_f32_dpp v19, v46, v19 row_ror:12 row_mask:0xf bank_mask:0x2
    v_add_f32_dpp v19, v47, v19 row_ror:8 row_mask:0xf bank_mask:0x2
    v_mov_b32_dpp v19, v48 row_ror:8 row_mask:0xf bank_mask:0x4
    v_add_f32_dpp v19, v49, v19 row_ror:4 row_mask:0xf bank_mask:0x4
    v_add_f32_dpp v19, v50, v19 quad_perm:[0,1,2,3] row_mask:0xf bank_mask:0x4
    v_add_f32_dpp v19, v51, v19 row_ror:12 row_mask:0xf bank_mask:0x4
    v_mov_b32_dpp v19, v52 row_ror:12 row_mask:0xf bank_mask:0x8
    v_add_f32_dpp v19, v53, v19 row_ror:8 row_mask:0xf bank_mask:0x8
    v_add_f32_dpp v19, v54, v19 row_ror:4 row_mask:0xf bank_mask:0x8
    v_add_f32_dpp v19, v55, v19 quad_perm:[0,1,2,3] row_mask:0xf bank_mask:0x8
    v_mfma_f32_16x16x32_bf16 v[40:43], v[252:255], v[8:11], 0
    v_mov_b32_dpp v20, v24 quad_perm:[0,1,2,3] row_mask:0xf bank_mask:0x1
    v_add_f32_dpp v20, v25, v20 row_ror:12 row_mask:0xf bank_mask:0x1
    v_add_f32_dpp v20, v26, v20 row_ror:8 row_mask:0xf bank_mask:0x1
    v_add_f32_dpp v20, v27, v20 row_ror:4 row_mask:0xf bank_mask:0x1
    v_mov_b32_dpp v20, v28 row_ror:4 row_mask:0xf bank_mask:0x2
    v_add_f32_dpp v20, v29, v20 quad_perm:[0,1,2,3] row_mask:0xf bank_mask:0x2
    v_add_f32_dpp v20, v30, v20 row_ror:12 row_mask:0xf bank_mask:0x2
    v_add_f32_dpp v20, v31, v20 row_ror:8 row_mask:0xf bank_mask:0x2
    v_mov_b32_dpp v20, v32 row_ror:8 row_mask:0xf bank_mask:0x4
    v_add_f32_dpp v20, v33, v20 row_ror:4 row_mask:0xf bank_mask:0x4
    v_add_f32_dpp v20, v34, v20 quad_perm:[0,1,2,3] row_mask:0xf bank_mask:0x4
    v_add_f32_dpp v20, v35, v20 row_ror:12 row_mask:0xf bank_mask:0x4
    v_mov_b32_dpp v20, v36 row_ror:12 row_mask:0xf bank_mask:0x8
    v_add_f32_dpp v20, v37, v20 row_ror:8 row_mask:0xf bank_mask:0x8
    v_add_f32_dpp v20, v38, v20 row_ror:4 row_mask:0xf bank_mask:0x8
    v_add_f32_dpp v20, v39, v20 quad_perm:[0,1,2,3] row_mask:0xf bank_mask:0x8
    v_mfma_f32_16x16x32_bf16 v[24:27], v[108:111], v[8:11], 0
    v_mfma_f32_16x16x32_bf16 v[28:31], v[112:115], v[8:11], 0
    v_mfma_f32_16x16x32_bf16 v[32:35], v[116:119], v[8:11], 0
    v_mfma_f32_16x16x32_bf16 v[36:39], v[120:123], v[8:11], 0
    v_mov_b32_dpp v21, v40 quad_perm:[0,1,2,3] row_mask:0xf bank_mask:0x1
    v_add_f32_dpp v21, v41, v21 row_ror:12 row_mask:0xf bank_mask:0x1
    v_add_f32_dpp v21, v42, v21 row_ror:8 row_mask:0xf bank_mask:0x1
    v_add_f32_dpp v21, v43, v21 row_ror:4 row_mask:0xf bank_mask:0x1
    ds_read_b128 v[108:111], v5 offset:0
    ds_read_b128 v[112:115], v5 offset:1024
    ds_read_b128 v[116:119], v5 offset:2048
    ds_read_b128 v[120:123], v5 offset:3072
    v_mfma_f32_16x16x32_bf16 v[40:43], v[124:127], v[8:11], 0
    v_mfma_f32_16x16x32_bf16 v[44:47], v[128:131], v[8:11], 0
    v_mfma_f32_16x16x32_bf16 v[48:51], v[132:135], v[8:11], 0
    v_mfma_f32_16x16x32_bf16 v[52:55], v[136:139], v[8:11], 0
    v_mov_b32_dpp v12, v24 quad_perm:[0,1,2,3] row_mask:0xf bank_mask:0x1
    v_add_f32_dpp v12, v25, v12 row_ror:12 row_mask:0xf bank_mask:0x1
    v_add_f32_dpp v12, v26, v12 row_ror:8 row_mask:0xf bank_mask:0x1
    v_add_f32_dpp v12, v27, v12 row_ror:4 row_mask:0xf bank_mask:0x1
    v_mov_b32_dpp v12, v28 row_ror:4 row_mask:0xf bank_mask:0x2
    v_add_f32_dpp v12, v29, v12 quad_perm:[0,1,2,3] row_mask:0xf bank_mask:0x2
    v_add_f32_dpp v12, v30, v12 row_ror:12 row_mask:0xf bank_mask:0x2
    v_add_f32_dpp v12, v31, v12 row_ror:8 row_mask:0xf bank_mask:0x2
    v_mov_b32_dpp v12, v32 row_ror:8 row_mask:0xf bank_mask:0x4
    v_add_f32_dpp v12, v33, v12 row_ror:4 row_mask:0xf bank_mask:0x4
    v_add_f32_dpp v12, v34, v12 quad_perm:[0,1,2,3] row_mask:0xf bank_mask:0x4
    v_add_f32_dpp v12, v35, v12 row_ror:12 row_mask:0xf bank_mask:0x4
    v_mov_b32_dpp v12, v36 row_ror:12 row_mask:0xf bank_mask:0x8
    v_add_f32_dpp v12, v37, v12 row_ror:8 row_mask:0xf bank_mask:0x8
    v_add_f32_dpp v12, v38, v12 row_ror:4 row_mask:0xf bank_mask:0x8
    v_add_f32_dpp v12, v39, v12 quad_perm:[0,1,2,3] row_mask:0xf bank_mask:0x8
    ds_read_b128 v[124:127], v5 offset:4096
    ds_read_b128 v[128:131], v5 offset:5120
    ds_read_b128 v[132:135], v5 offset:6144
    ds_read_b128 v[136:139], v5 offset:7168
    v_mfma_f32_16x16x32_bf16 v[24:27], v[140:143], v[8:11], 0
    v_mfma_f32_16x16x32_bf16 v[28:31], v[144:147], v[8:11], 0
    v_mfma_f32_16x16x32_bf16 v[32:35], v[148:151], v[8:11], 0
    v_mfma_f32_16x16x32_bf16 v[36:39], v[152:155], v[8:11], 0
    v_mov_b32_dpp v13, v40 quad_perm:[0,1,2,3] row_mask:0xf bank_mask:0x1
    v_add_f32_dpp v13, v41, v13 row_ror:12 row_mask:0xf bank_mask:0x1
    v_add_f32_dpp v13, v42, v13 row_ror:8 row_mask:0xf bank_mask:0x1
    v_add_f32_dpp v13, v43, v13 row_ror:4 row_mask:0xf bank_mask:0x1
    v_mov_b32_dpp v13, v44 row_ror:4 row_mask:0xf bank_mask:0x2
    v_add_f32_dpp v13, v45, v13 quad_perm:[0,1,2,3] row_mask:0xf bank_mask:0x2
    v_add_f32_dpp v13, v46, v13 row_ror:12 row_mask:0xf bank_mask:0x2
    v_add_f32_dpp v13, v47, v13 row_ror:8 row_mask:0xf bank_mask:0x2
    v_mov_b32_dpp v13, v48 row_ror:8 row_mask:0xf bank_mask:0x4
    v_add_f32_dpp v13, v49, v13 row_ror:4 row_mask:0xf bank_mask:0x4
    v_add_f32_dpp v13, v50, v13 quad_perm:[0,1,2,3] row_mask:0xf bank_mask:0x4
    v_add_f32_dpp v13, v51, v13 row_ror:12 row_mask:0xf bank_mask:0x4
    v_mov_b32_dpp v13, v52 row_ror:12 row_mask:0xf bank_mask:0x8
    v_add_f32_dpp v13, v53, v13 row_ror:8 row_mask:0xf bank_mask:0x8
    v_add_f32_dpp v13, v54, v13 row_ror:4 row_mask:0xf bank_mask:0x8
    v_add_f32_dpp v13, v55, v13 quad_perm:[0,1,2,3] row_mask:0xf bank_mask:0x8
    ds_read_b128 v[140:143], v5 offset:8192
    ds_read_b128 v[144:147], v5 offset:9216
    ds_read_b128 v[148:151], v5 offset:10240
    ds_read_b128 v[152:155], v5 offset:11264
    v_mfma_f32_16x16x32_bf16 v[40:43], v[156:159], v[8:11], 0
    v_mfma_f32_16x16x32_bf16 v[44:47], v[160:163], v[8:11], 0
    v_mfma_f32_16x16x32_bf16 v[48:51], v[164:167], v[8:11], 0
    v_mfma_f32_16x16x32_bf16 v[52:55], v[168:171], v[8:11], 0
    v_mov_b32_dpp v14, v24 quad_perm:[0,1,2,3] row_mask:0xf bank_mask:0x1
    v_add_f32_dpp v14, v25, v14 row_ror:12 row_mask:0xf bank_mask:0x1
    v_add_f32_dpp v14, v26, v14 row_ror:8 row_mask:0xf bank_mask:0x1
    v_add_f32_dpp v14, v27, v14 row_ror:4 row_mask:0xf bank_mask:0x1
    v_mov_b32_dpp v14, v28 row_ror:4 row_mask:0xf bank_mask:0x2
    v_add_f32_dpp v14, v29, v14 quad_perm:[0,1,2,3] row_mask:0xf bank_mask:0x2
    v_add_f32_dpp v14, v30, v14 row_ror:12 row_mask:0xf bank_mask:0x2
    v_add_f32_dpp v14, v31, v14 row_ror:8 row_mask:0xf bank_mask:0x2
    v_mov_b32_dpp v14, v32 row_ror:8 row_mask:0xf bank_mask:0x4
    v_add_f32_dpp v14, v33, v14 row_ror:4 row_mask:0xf bank_mask:0x4
    v_add_f32_dpp v14, v34, v14 quad_perm:[0,1,2,3] row_mask:0xf bank_mask:0x4
    v_add_f32_dpp v14, v35, v14 row_ror:12 row_mask:0xf bank_mask:0x4
    v_mov_b32_dpp v14, v36 row_ror:12 row_mask:0xf bank_mask:0x8
    v_add_f32_dpp v14, v37, v14 row_ror:8 row_mask:0xf bank_mask:0x8
    v_add_f32_dpp v14, v38, v14 row_ror:4 row_mask:0xf bank_mask:0x8
    v_add_f32_dpp v14, v39, v14 quad_perm:[0,1,2,3] row_mask:0xf bank_mask:0x8
    s_waitcnt vmcnt(4)
    ds_read_b128 v[156:159], v5 offset:12288
    ds_read_b128 v[160:163], v5 offset:13312
    ds_read_b128 v[164:167], v5 offset:14336
    ds_read_b128 v[168:171], v5 offset:15360
    v_mov_b32_dpp v15, v40 quad_perm:[0,1,2,3] row_mask:0xf bank_mask:0x1
    v_add_f32_dpp v15, v41, v15 row_ror:12 row_mask:0xf bank_mask:0x1
    v_add_f32_dpp v15, v42, v15 row_ror:8 row_mask:0xf bank_mask:0x1
    v_add_f32_dpp v15, v43, v15 row_ror:4 row_mask:0xf bank_mask:0x1
    v_mov_b32_dpp v15, v44 row_ror:4 row_mask:0xf bank_mask:0x2
    v_add_f32_dpp v15, v45, v15 quad_perm:[0,1,2,3] row_mask:0xf bank_mask:0x2
    v_add_f32_dpp v15, v46, v15 row_ror:12 row_mask:0xf bank_mask:0x2
    v_add_f32_dpp v15, v47, v15 row_ror:8 row_mask:0xf bank_mask:0x2
    v_mov_b32_dpp v15, v48 row_ror:8 row_mask:0xf bank_mask:0x4
    v_add_f32_dpp v15, v49, v15 row_ror:4 row_mask:0xf bank_mask:0x4
    v_add_f32_dpp v15, v50, v15 quad_perm:[0,1,2,3] row_mask:0xf bank_mask:0x4
    v_add_f32_dpp v15, v51, v15 row_ror:12 row_mask:0xf bank_mask:0x4
    v_mov_b32_dpp v15, v52 row_ror:12 row_mask:0xf bank_mask:0x8
    v_add_f32_dpp v15, v53, v15 row_ror:8 row_mask:0xf bank_mask:0x8
    v_add_f32_dpp v15, v54, v15 row_ror:4 row_mask:0xf bank_mask:0x8
    v_add_f32_dpp v15, v55, v15 quad_perm:[0,1,2,3] row_mask:0xf bank_mask:0x8
    v_add_f32 v21, s56, v21
    v_max3_f32 v22, v12, v13, v14
    v_max3_f32 v22, v22, v15, v16
    v_max3_f32 v22, v22, v17, v18
    v_max3_f32 v22, v22, v19, v20
    v_max_f32 v22, v22, v21
    s_nop 1
    v_max_f32_dpp v22, v22, v22 row_ror:4 row_mask:0xf bank_mask:0xf
    s_nop 1
    v_max_f32_dpp v22, v22, v22 row_ror:8 row_mask:0xf bank_mask:0xf
    v_mov_b32 v6, v22
    s_nop 1
    v_permlane16_swap_b32 v22, v6
    v_max_f32 v22, v22, v6
    v_mov_b32 v6, v22
    s_nop 1
    v_permlane32_swap_b32 v22, v6
    v_max_f32 v22, v22, v6
    v_mul_f32 v22, s57, v22
    v_fma_f32 v12, v12, s57, -v22
    v_fma_f32 v13, v13, s57, -v22
    v_fma_f32 v14, v14, s57, -v22
    v_fma_f32 v15, v15, s57, -v22
    v_fma_f32 v16, v16, s57, -v22
    v_fma_f32 v17, v17, s57, -v22
    v_fma_f32 v18, v18, s57, -v22
    v_fma_f32 v19, v19, s57, -v22
    v_fma_f32 v20, v20, s57, -v22
    v_fma_f32 v21, v21, s57, -v22
    v_exp_f32 v12, v12
    v_exp_f32 v13, v13
    v_exp_f32 v14, v14
    v_exp_f32 v15, v15
    v_exp_f32 v16, v16
    v_exp_f32 v17, v17
    v_exp_f32 v18, v18
    v_exp_f32 v19, v19
    v_exp_f32 v20, v20
    v_exp_f32 v21, v21
    s_waitcnt vmcnt(3)
    s_add_u32 s53, s52, 20480
    buffer_load_dwordx4 v[188:191], v3, s[40:43], s53 offen offset:0 nt
    s_waitcnt vmcnt(3)
    buffer_load_dwordx4 v[192:195], v3, s[40:43], s53 offen offset:1024 nt
    v_add_f32 v23, v12, v13
    v_add_f32 v23, v23, v14
    v_add_f32 v23, v23, v15
    v_add_f32 v23, v23, v16
    v_add_f32 v23, v23, v17
    v_add_f32 v23, v23, v18
    v_add_f32 v23, v23, v19
    v_add_f32 v23, v23, v20
    v_add_f32 v23, v23, v21
    v_cvt_pk_bf16_f32 v12, v12, v13
    v_cvt_pk_bf16_f32 v14, v14, v15
    v_cvt_pk_bf16_f32 v16, v16, v17
    v_cvt_pk_bf16_f32 v18, v18, v19
    v_cvt_pk_bf16_f32 v20, v20, v21
    v_add_f32_dpp v23, v23, v23 row_ror:4 row_mask:0xf bank_mask:0xf
    s_nop 1
    v_add_f32_dpp v23, v23, v23 row_ror:8 row_mask:0xf bank_mask:0xf
    v_mov_b32 v6, v23
    s_nop 1
    v_permlane16_swap_b32 v23, v6
    v_add_f32 v23, v23, v6
    v_mov_b32 v6, v23
    s_nop 1
    v_permlane32_swap_b32 v23, v6
    v_add_f32 v23, v23, v6
    s_lshl_b32 s91, s3, 5
    v_lshlrev_b32 v6, 3, v1
    v_add_u32 v6, s91, v6
    s_mov_b64 exec, 0xf
    ds_write_b64 v6, v[22:23] offset:16384
    s_mov_b64 exec, 1
    v_mov_b32 v6, 16768
    v_mov_b32 v7, 1
    s_waitcnt lgkmcnt(0)
    ds_add_rtn_u32 v30, v6, v7
    s_waitcnt lgkmcnt(0)
    v_readfirstlane_b32 s91, v30
    s_mov_b64 exec, -1
    s_cmp_lg_u32 s91, 7
    s_cbranch_scc1 L_mlpub_3
    v_and_b32 v6, 31, v1
    v_lshlrev_b32 v7, 3, v6
    ds_read_b64 v[30:31], v7 offset:16384
    v_lshlrev_b32 v6, 2, v6
    s_waitcnt lgkmcnt(0)
    v_mov_b32 v36, v30
    s_nop 1
    v_max_f32_dpp v36, v36, v36 row_ror:4 row_mask:0xf bank_mask:0xf
    s_nop 1
    v_max_f32_dpp v36, v36, v36 row_ror:8 row_mask:0xf bank_mask:0xf
    v_mov_b32 v32, v36
    s_nop 1
    v_permlane16_swap_b32 v36, v32
    v_max_f32 v36, v36, v32
    v_mov_b32_sdwa v36, s100 dst_sel:BYTE_0 dst_unused:UNUSED_PRESERVE src0_sel:DWORD
    s_nop 0
    v_sub_f32 v30, v30, v36
    v_exp_f32 v30, v30
    s_nop 0
    v_mul_f32 v37, v30, v31
    ds_write_b32 v6, v30 offset:16640
    s_nop 0
    v_add_f32_dpp v37, v37, v37 row_ror:4 row_mask:0xf bank_mask:0xf
    s_nop 1
    v_add_f32_dpp v37, v37, v37 row_ror:8 row_mask:0xf bank_mask:0xf
    v_mov_b32 v32, v37
    s_nop 1
    v_permlane16_swap_b32 v37, v32
    v_add_f32 v37, v37, v32
    v_mov_b32_sdwa v37, s100 dst_sel:BYTE_0 dst_unused:UNUSED_PRESERVE src0_sel:DWORD
    v_mov_b32 v38, v36
    v_mov_b32 v39, v37
    v_and_b32 v6, 3, v1
    v_lshlrev_b32 v6, 4, v6
    v_bfe_u32 v7, v1, 2, 1
    v_lshl_add_u32 v6, v7, 6, v6
    s_mov_b64 exec, 0xff
    buffer_store_dwordx4 v[36:39], v6, s[44:47], s59 offen sc1
    s_mov_b64 exec, -1
L_mlpub_3:
    v_lshrrev_b32 v6, 2, v1
    s_lshl_b32 s91, s3, 4
    v_add_u32 v6, s91, v6
    v_lshlrev_b32 v6, 4, v6
    v_and_b32 v7, 3, v1
    v_lshl_add_u32 v24, v7, 12, v6
    v_cmp_eq_u32 s[92:93], 0, v7
    v_mov_b32 v26, 268435456
    s_nop 0
    v_cndmask_b32 v26, v26, v6, s[92:93]
    s_lshr_b32 s91, s3, 1
    s_lshl_b32 s91, s91, 2
    s_add_u32 s91, s91, 16640
    v_lshl_add_u32 v25, v7, 5, s91
    s_lshl_b32 s91, s3, 11
    v_lshl_add_u32 v27, v1, 5, s91
    v_add_u32 v28, 1024, v27
    s_waitcnt vmcnt(3)
    buffer_load_dwordx4 v[196:199], v3, s[40:43], s53 offen offset:2048 nt
    s_waitcnt vmcnt(3)
    buffer_load_dwordx4 v[200:203], v3, s[40:43], s53 offen offset:3072 nt
    s_waitcnt lgkmcnt(0)
    v_mov_b32 v104, v12
    v_mov_b32_dpp v105, v12 row_shl:4 row_mask:0xf bank_mask:0xf
    v_mov_b32_dpp v106, v12 row_shl:8 row_mask:0xf bank_mask:0xf
    v_mov_b32_dpp v107, v12 row_shl:12 row_mask:0xf bank_mask:0xf
    v_perm_b32 v88, v124, v108, s94
    v_perm_b32 v92, v124, v108, s95
    v_perm_b32 v89, v128, v112, s94
    v_perm_b32 v93, v128, v112, s95
    v_perm_b32 v90, v132, v116, s94
    v_perm_b32 v94, v132, v116, s95
    v_perm_b32 v91, v136, v120, s94
    v_perm_b32 v95, v136, v120, s95
    s_nop 0
    v_mfma_f32_16x16x32_bf16 v[56:59], v[104:107], v[88:91], 0
    v_mfma_f32_16x16x32_bf16 v[60:63], v[104:107], v[92:95], 0
    v_perm_b32 v96, v125, v109, s94
    v_perm_b32 v100, v125, v109, s95
    v_perm_b32 v97, v129, v113, s94
    v_perm_b32 v101, v129, v113, s95
    v_perm_b32 v98, v133, v117, s94
    v_perm_b32 v102, v133, v117, s95
    v_perm_b32 v99, v137, v121, s94
    v_perm_b32 v103, v137, v121, s95
    s_nop 0
    v_mfma_f32_16x16x32_bf16 v[64:67], v[104:107], v[96:99], 0
    v_mfma_f32_16x16x32_bf16 v[68:71], v[104:107], v[100:103], 0
    v_perm_b32 v88, v126, v110, s94
    v_perm_b32 v92, v126, v110, s95
    v_perm_b32 v89, v130, v114, s94
    v_perm_b32 v93, v130, v114, s95
    v_perm_b32 v90, v134, v118, s94
    v_perm_b32 v94, v134, v118, s95
    v_perm_b32 v91, v138, v122, s94
    v_perm_b32 v95, v138, v122, s95
    s_nop 0
    v_mfma_f32_16x16x32_bf16 v[72:75], v[104:107], v[88:91], 0
    v_mfma_f32_16x16x32_bf16 v[76:79], v[104:107], v[92:95], 0
    v_perm_b32 v96, v127, v111, s94
    v_perm_b32 v100, v127, v111, s95
    v_perm_b32 v97, v131, v115, s94
    v_perm_b32 v101, v131, v115, s95
    v_perm_b32 v98, v135, v119, s94
    v_perm_b32 v102, v135, v119, s95
    v_perm_b32 v99, v139, v123, s94
    v_perm_b32 v103, v139, v123, s95
    s_nop 0
    v_mfma_f32_16x16x32_bf16 v[80:83], v[104:107], v[96:99], 0
    v_mfma_f32_16x16x32_bf16 v[84:87], v[104:107], v[100:103], 0
    s_waitcnt vmcnt(3)
    s_add_u32 s53, s52, 24576
    buffer_load_dwordx4 v[204:207], v3, s[40:43], s53 offen offset:0 nt
    s_waitcnt vmcnt(3)
    buffer_load_dwordx4 v[208:211], v3, s[40:43], s53 offen offset:1024 nt
    s_waitcnt lgkmcnt(0)
    v_mov_b32 v104, v14
    v_mov_b32_dpp v105, v14 row_shl:4 row_mask:0xf bank_mask:0xf
    v_mov_b32_dpp v106, v14 row_shl:8 row_mask:0xf bank_mask:0xf
    v_mov_b32_dpp v107, v14 row_shl:12 row_mask:0xf bank_mask:0xf
    v_perm_b32 v88, v156, v140, s94
    v_perm_b32 v92, v156, v140, s95
    v_perm_b32 v89, v160, v144, s94
    v_perm_b32 v93, v160, v144, s95
    v_perm_b32 v90, v164, v148, s94
    v_perm_b32 v94, v164, v148, s95
    v_perm_b32 v91, v168, v152, s94
    v_perm_b32 v95, v168, v152, s95
    s_nop 0
    v_mfma_f32_16x16x32_bf16 v[56:59], v[104:107], v[88:91], v[56:59]
    v_mfma_f32_16x16x32_bf16 v[60:63], v[104:107], v[92:95], v[60:63]
    v_perm_b32 v96, v157, v141, s94
    v_perm_b32 v100, v157, v141, s95
    v_perm_b32 v97, v161, v145, s94
    v_perm_b32 v101, v161, v145, s95
    v_perm_b32 v98, v165, v149, s94
    v_perm_b32 v102, v165, v149, s95
    v_perm_b32 v99, v169, v153, s94
    v_perm_b32 v103, v169, v153, s95
    s_nop 0
    v_mfma_f32_16x16x32_bf16 v[64:67], v[104:107], v[96:99], v[64:67]
    v_mfma_f32_16x16x32_bf16 v[68:71], v[104:107], v[100:103], v[68:71]
    v_perm_b32 v88, v158, v142, s94
    v_perm_b32 v92, v158, v142, s95
    v_perm_b32 v89, v162, v146, s94
    v_perm_b32 v93, v162, v146, s95
    v_perm_b32 v90, v166, v150, s94
    v_perm_b32 v94, v166, v150, s95
    v_perm_b32 v91, v170, v154, s94
    v_perm_b32 v95, v170, v154, s95
    s_nop 0
    v_mfma_f32_16x16x32_bf16 v[72:75], v[104:107], v[88:91], v[72:75]
    v_mfma_f32_16x16x32_bf16 v[76:79], v[104:107], v[92:95], v[76:79]
    v_perm_b32 v96, v159, v143, s94
    v_perm_b32 v100, v159, v143, s95
    v_perm_b32 v97, v163, v147, s94
    v_perm_b32 v101, v163, v147, s95
    v_perm_b32 v98, v167, v151, s94
    v_perm_b32 v102, v167, v151, s95
    v_perm_b32 v99, v171, v155, s94
    v_perm_b32 v103, v171, v155, s95
    s_nop 0
    v_mfma_f32_16x16x32_bf16 v[80:83], v[104:107], v[96:99], v[80:83]
    v_mfma_f32_16x16x32_bf16 v[84:87], v[104:107], v[100:103], v[84:87]
    s_waitcnt vmcnt(3)
    buffer_load_dwordx4 v[212:215], v3, s[40:43], s53 offen offset:2048 nt
    s_waitcnt vmcnt(3)
    buffer_load_dwordx4 v[216:219], v3, s[40:43], s53 offen offset:3072 nt
    v_mov_b32 v104, v16
    v_mov_b32_dpp v105, v16 row_shl:4 row_mask:0xf bank_mask:0xf
    v_mov_b32_dpp v106, v16 row_shl:8 row_mask:0xf bank_mask:0xf
    v_mov_b32_dpp v107, v16 row_shl:12 row_mask:0xf bank_mask:0xf
    v_perm_b32 v88, v188, v172, s94
    v_perm_b32 v92, v188, v172, s95
    v_perm_b32 v89, v192, v176, s94
    v_perm_b32 v93, v192, v176, s95
    v_perm_b32 v90, v196, v180, s94
    v_perm_b32 v94, v196, v180, s95
    v_perm_b32 v91, v200, v184, s94
    v_perm_b32 v95, v200, v184, s95
    s_nop 0
    v_mfma_f32_16x16x32_bf16 v[56:59], v[104:107], v[88:91], v[56:59]
    v_mfma_f32_16x16x32_bf16 v[60:63], v[104:107], v[92:95], v[60:63]
    v_perm_b32 v96, v189, v173, s94
    v_perm_b32 v100, v189, v173, s95
    v_perm_b32 v97, v193, v177, s94
    v_perm_b32 v101, v193, v177, s95
    v_perm_b32 v98, v197, v181, s94
    v_perm_b32 v102, v197, v181, s95
    v_perm_b32 v99, v201, v185, s94
    v_perm_b32 v103, v201, v185, s95
    s_nop 0
    v_mfma_f32_16x16x32_bf16 v[64:67], v[104:107], v[96:99], v[64:67]
    v_mfma_f32_16x16x32_bf16 v[68:71], v[104:107], v[100:103], v[68:71]
    v_perm_b32 v88, v190, v174, s94
    v_perm_b32 v92, v190, v174, s95
    v_perm_b32 v89, v194, v178, s94
    v_perm_b32 v93, v194, v178, s95
    v_perm_b32 v90, v198, v182, s94
    v_perm_b32 v94, v198, v182, s95
    v_perm_b32 v91, v202, v186, s94
    v_perm_b32 v95, v202, v186, s95
    s_nop 0
    v_mfma_f32_16x16x32_bf16 v[72:75], v[104:107], v[88:91], v[72:75]
    v_mfma_f32_16x16x32_bf16 v[76:79], v[104:107], v[92:95], v[76:79]
    v_perm_b32 v96, v191, v175, s94
    v_perm_b32 v100, v191, v175, s95
    v_perm_b32 v97, v195, v179, s94
    v_perm_b32 v101, v195, v179, s95
    v_perm_b32 v98, v199, v183, s94
    v_perm_b32 v102, v199, v183, s95
    v_perm_b32 v99, v203, v187, s94
    v_perm_b32 v103, v203, v187, s95
    s_nop 0
    v_mfma_f32_16x16x32_bf16 v[80:83], v[104:107], v[96:99], v[80:83]
    v_mfma_f32_16x16x32_bf16 v[84:87], v[104:107], v[100:103], v[84:87]
    s_waitcnt vmcnt(3)
    s_add_u32 s53, s52, 28672
    buffer_load_dwordx4 v[220:223], v3, s[40:43], s53 offen offset:0 nt
    s_waitcnt vmcnt(3)
    buffer_load_dwordx4 v[224:227], v3, s[40:43], s53 offen offset:1024 nt
    s_waitcnt vmcnt(3)
    buffer_load_dwordx4 v[228:231], v3, s[40:43], s53 offen offset:2048 nt
    s_waitcnt vmcnt(3)
    buffer_load_dwordx4 v[232:235], v3, s[40:43], s53 offen offset:3072 nt
    s_waitcnt vmcnt(3)
    s_add_u32 s53, s52, 32768
    buffer_load_dwordx4 v[236:239], v3, s[40:43], s53 offen offset:0 nt
    s_waitcnt vmcnt(3)
    buffer_load_dwordx4 v[240:243], v3, s[40:43], s53 offen offset:1024 nt
    s_waitcnt vmcnt(3)
    buffer_load_dwordx4 v[244:247], v3, s[40:43], s53 offen offset:2048 nt
    s_waitcnt vmcnt(3)
    buffer_load_dwordx4 v[248:251], v3, s[40:43], s53 offen offset:3072 nt
    v_mov_b32 v104, v18
    v_mov_b32_dpp v105, v18 row_shl:4 row_mask:0xf bank_mask:0xf
    v_mov_b32_dpp v106, v18 row_shl:8 row_mask:0xf bank_mask:0xf
    v_mov_b32_dpp v107, v18 row_shl:12 row_mask:0xf bank_mask:0xf
    v_perm_b32 v88, v220, v204, s94
    v_perm_b32 v92, v220, v204, s95
    v_perm_b32 v89, v224, v208, s94
    v_perm_b32 v93, v224, v208, s95
    v_perm_b32 v90, v228, v212, s94
    v_perm_b32 v94, v228, v212, s95
    v_perm_b32 v91, v232, v216, s94
    v_perm_b32 v95, v232, v216, s95
    s_nop 0
    v_mfma_f32_16x16x32_bf16 v[56:59], v[104:107], v[88:91], v[56:59]
    v_mfma_f32_16x16x32_bf16 v[60:63], v[104:107], v[92:95], v[60:63]
    v_perm_b32 v96, v221, v205, s94
    v_perm_b32 v100, v221, v205, s95
    v_perm_b32 v97, v225, v209, s94
    v_perm_b32 v101, v225, v209, s95
    v_perm_b32 v98, v229, v213, s94
    v_perm_b32 v102, v229, v213, s95
    v_perm_b32 v99, v233, v217, s94
    v_perm_b32 v103, v233, v217, s95
    s_nop 0
    v_mfma_f32_16x16x32_bf16 v[64:67], v[104:107], v[96:99], v[64:67]
    v_mfma_f32_16x16x32_bf16 v[68:71], v[104:107], v[100:103], v[68:71]
    v_perm_b32 v88, v222, v206, s94
    v_perm_b32 v92, v222, v206, s95
    v_perm_b32 v89, v226, v210, s94
    v_perm_b32 v93, v226, v210, s95
    v_perm_b32 v90, v230, v214, s94
    v_perm_b32 v94, v230, v214, s95
    v_perm_b32 v91, v234, v218, s94
    v_perm_b32 v95, v234, v218, s95
    s_nop 0
    v_mfma_f32_16x16x32_bf16 v[72:75], v[104:107], v[88:91], v[72:75]
    v_mfma_f32_16x16x32_bf16 v[76:79], v[104:107], v[92:95], v[76:79]
    v_perm_b32 v96, v223, v207, s94
    v_perm_b32 v100, v223, v207, s95
    v_perm_b32 v97, v227, v211, s94
    v_perm_b32 v101, v227, v211, s95
    v_perm_b32 v98, v231, v215, s94
    v_perm_b32 v102, v231, v215, s95
    v_perm_b32 v99, v235, v219, s94
    v_perm_b32 v103, v235, v219, s95
    s_nop 0
    v_mfma_f32_16x16x32_bf16 v[80:83], v[104:107], v[96:99], v[80:83]
    v_mfma_f32_16x16x32_bf16 v[84:87], v[104:107], v[100:103], v[84:87]
    s_waitcnt vmcnt(3)
    buffer_load_dwordx4 v[252:255], v3, s[40:43], s54 offen nt
    s_waitcnt vmcnt(0)
    v_mov_b32 v104, v20
    v_mov_b32_dpp v105, v20 row_shl:4 row_mask:0xf bank_mask:0xf
    v_mov_b32_dpp v106, v20 row_shl:8 row_mask:0xf bank_mask:0xf
    v_mov_b32_dpp v107, v20 row_shl:12 row_mask:0xf bank_mask:0xf
    v_perm_b32 v88, v252, v236, s94
    v_perm_b32 v92, v252, v236, s95
    v_perm_b32 v89, v240, v240, s94
    v_perm_b32 v93, v240, v240, s95
    v_perm_b32 v90, v244, v244, s94
    v_perm_b32 v94, v244, v244, s95
    v_perm_b32 v91, v248, v248, s94
    v_perm_b32 v95, v248, v248, s95
    s_nop 0
    v_mfma_f32_16x16x32_bf16 v[56:59], v[104:107], v[88:91], v[56:59]
    v_mfma_f32_16x16x32_bf16 v[60:63], v[104:107], v[92:95], v[60:63]
    v_perm_b32 v96, v253, v237, s94
    v_perm_b32 v100, v253, v237, s95
    v_perm_b32 v97, v241, v241, s94
    v_perm_b32 v101, v241, v241, s95
    v_perm_b32 v98, v245, v245, s94
    v_perm_b32 v102, v245, v245, s95
    v_perm_b32 v99, v249, v249, s94
    v_perm_b32 v103, v249, v249, s95
    s_nop 0
    v_mfma_f32_16x16x32_bf16 v[64:67], v[104:107], v[96:99], v[64:67]
    v_mfma_f32_16x16x32_bf16 v[68:71], v[104:107], v[100:103], v[68:71]
    v_perm_b32 v88, v254, v238, s94
    v_perm_b32 v92, v254, v238, s95
    v_perm_b32 v89, v242, v242, s94
    v_perm_b32 v93, v242, v242, s95
    v_perm_b32 v90, v246, v246, s94
    v_perm_b32 v94, v246, v246, s95
    v_perm_b32 v91, v250, v250, s94
    v_perm_b32 v95, v250, v250, s95
    s_nop 0
    v_mfma_f32_16x16x32_bf16 v[72:75], v[104:107], v[88:91], v[72:75]
    v_mfma_f32_16x16x32_bf16 v[76:79], v[104:107], v[92:95], v[76:79]
    v_perm_b32 v96, v255, v239, s94
    v_perm_b32 v100, v255, v239, s95
    v_perm_b32 v97, v243, v243, s94
    v_perm_b32 v101, v243, v243, s95
    v_perm_b32 v98, v247, v247, s94
    v_perm_b32 v102, v247, v247, s95
    v_perm_b32 v99, v251, v251, s94
    v_perm_b32 v103, v251, v251, s95
    s_nop 0
    v_mfma_f32_16x16x32_bf16 v[80:83], v[104:107], v[96:99], v[80:83]
    v_mfma_f32_16x16x32_bf16 v[84:87], v[104:107], v[100:103], v[84:87]
    s_mov_b64 exec, 0xffff
    ds_write2_b32 v27, v56, v60 offset0:0 offset1:1
    ds_write2_b32 v27, v57, v61 offset0:128 offset1:129
    ds_write2_b32 v28, v58, v62 offset0:0 offset1:1
    ds_write2_b32 v28, v59, v63 offset0:128 offset1:129
    ds_write2_b32 v27, v64, v68 offset0:2 offset1:3
    ds_write2_b32 v27, v65, v69 offset0:130 offset1:131
    ds_write2_b32 v28, v66, v70 offset0:2 offset1:3
    ds_write2_b32 v28, v67, v71 offset0:130 offset1:131
    ds_write2_b32 v27, v72, v76 offset0:4 offset1:5
    ds_write2_b32 v27, v73, v77 offset0:132 offset1:133
    ds_write2_b32 v28, v74, v78 offset0:4 offset1:5
    ds_write2_b32 v28, v75, v79 offset0:132 offset1:133
    ds_write2_b32 v27, v80, v84 offset0:6 offset1:7
    ds_write2_b32 v27, v81, v85 offset0:134 offset1:135
    ds_write2_b32 v28, v82, v86 offset0:6 offset1:7
    ds_write2_b32 v28, v83, v87 offset0:134 offset1:135
    s_mov_b64 exec, -1
    s_waitcnt lgkmcnt(0)
    s_barrier
    ds_read2_b32 v[30:31], v25 offset0:0 offset1:4
    ds_read_b128 v[36:39], v24
    ds_read_b128 v[40:43], v24 offset:2048
    s_waitcnt lgkmcnt(1)
    v_mul_f32 v36, v30, v36
    v_mul_f32 v37, v30, v37
    v_mul_f32 v38, v30, v38
    v_mul_f32 v39, v30, v39
    s_waitcnt lgkmcnt(0)
    v_fmac_f32 v36, v31, v40
    v_fmac_f32 v37, v31, v41
    v_fmac_f32 v38, v31, v42
    v_fmac_f32 v39, v31, v43
    v_add_f32_dpp v36, v36, v36 quad_perm:[1,0,3,2] row_mask:0xf bank_mask:0xf
    v_add_f32_dpp v37, v37, v37 quad_perm:[1,0,3,2] row_mask:0xf bank_mask:0xf
    v_add_f32_dpp v38, v38, v38 quad_perm:[1,0,3,2] row_mask:0xf bank_mask:0xf
    v_add_f32_dpp v39, v39, v39 quad_perm:[1,0,3,2] row_mask:0xf bank_mask:0xf
    v_add_f32_dpp v36, v36, v36 quad_perm:[2,3,0,1] row_mask:0xf bank_mask:0xf
    v_add_f32_dpp v37, v37, v37 quad_perm:[2,3,0,1] row_mask:0xf bank_mask:0xf
    v_add_f32_dpp v38, v38, v38 quad_perm:[2,3,0,1] row_mask:0xf bank_mask:0xf
    v_add_f32_dpp v39, v39, v39 quad_perm:[2,3,0,1] row_mask:0xf bank_mask:0xf
    v_mov_b32_sdwa v36, s100 dst_sel:BYTE_0 dst_unused:UNUSED_PRESERVE src0_sel:DWORD
    v_mov_b32_sdwa v37, s100 dst_sel:BYTE_0 dst_unused:UNUSED_PRESERVE src0_sel:DWORD
    v_mov_b32_sdwa v38, s100 dst_sel:BYTE_0 dst_unused:UNUSED_PRESERVE src0_sel:DWORD
    v_mov_b32_sdwa v39, s100 dst_sel:BYTE_0 dst_unused:UNUSED_PRESERVE src0_sel:DWORD
    s_nop 0
    buffer_store_dwordx4 v[36:39], v26, s[44:47], s58 offen sc1
    s_endpgm
L_service:
    v_mov_b32 v4, 1024
    v_mov_b32 v6, 0
    v_mov_b32 v7, 0
    ds_write_b64 v4, v[6:7]
    ds_write_b64 v4, v[6:7] offset:8
    s_waitcnt lgkmcnt(0)
    s_load_dword s100, s[34:35], 65536
    s_barrier
    s_mov_b32 s99, 100000
    s_mov_b32 s48, s26
    s_mov_b32 s49, s27
    s_mov_b32 s50, 1024
    s_mov_b32 s51, 0x20000
    s_mov_b32 s52, s28
    s_mov_b32 s53, s29
    s_mov_b32 s54, 3145728
    s_mov_b32 s55, 0x20000
    s_mov_b32 s36, s34
    s_mov_b32 s37, s35
    s_mov_b32 s38, 2097152
    s_mov_b32 s39, 0x20000
    s_mov_b32 s44, s8
    s_mov_b32 s45, s9
    s_mov_b32 s46, 1024
    s_mov_b32 s47, 0x20000
    s_mov_b32 s56, s14
    s_mov_b32 s57, s15
    s_mov_b32 s58, 4194304
    s_mov_b32 s59, 0x20000
    s_and_b32 s83, s81, 15
    s_lshr_b32 s60, s81, 4
    s_lshl_b32 s88, s60, 12
    s_lshl_b32 s89, s83, 8
    s_add_u32 s88, s88, s89
    s_lshl_b32 s82, s3, 9
    s_add_u32 s82, s82, 24832
    s_mov_b32 s94, 0x05040100
    s_mov_b32 s95, 0x07060302
    s_cmp_ge_u32 s3, 4
    s_cbranch_scc1 L_noa1i_4
    s_lshl_b32 s61, s60, 8
    s_lshl_b32 s62, s3, 6
    s_add_u32 s61, s61, s62
    v_lshlrev_b32 v4, 1, v1
    s_lshl_b32 s91, s61, 1
    buffer_load_ushort v22, v4, s[48:51], s91 offen
    v_lshrrev_b32 v5, 4, v1
    v_lshlrev_b32 v5, 3, v5
    v_bfe_u32 v6, v1, 3, 1
    v_lshlrev_b32 v6, 5, v6
    v_add_u32 v5, v5, v6
    v_mul_u32_u24 v5, 6144, v5
    v_and_b32 v6, 7, v1
    v_lshlrev_b32 v6, 4, v6
    v_add_u32 v19, v5, v6
    s_mul_i32 s63, s61, 6144
    s_lshl_b32 s62, s83, 7
    s_add_u32 s63, s63, s62
    buffer_load_dwordx4 v[96:99], v19, s[52:55], s63 offen nt
    s_add_u32 s63, s63, 6144
    buffer_load_dwordx4 v[100:103], v19, s[52:55], s63 offen nt
    s_add_u32 s63, s63, 6144
    buffer_load_dwordx4 v[104:107], v19, s[52:55], s63 offen nt
    s_add_u32 s63, s63, 6144
    buffer_load_dwordx4 v[108:111], v19, s[52:55], s63 offen nt
    s_add_u32 s63, s63, 6144
    buffer_load_dwordx4 v[112:115], v19, s[52:55], s63 offen nt
    s_add_u32 s63, s63, 6144
    buffer_load_dwordx4 v[116:119], v19, s[52:55], s63 offen nt
    s_add_u32 s63, s63, 6144
    buffer_load_dwordx4 v[120:123], v19, s[52:55], s63 offen nt
    s_add_u32 s63, s63, 6144
    buffer_load_dwordx4 v[124:127], v19, s[52:55], s63 offen nt
L_noa1i_4:
    v_lshlrev_b32 v7, 4, v1
    s_lshl_b32 s91, s3, 7
    v_lshlrev_b32 v2, 1, v1
    v_add_u32 v2, s91, v2
    v_lshrrev_b32 v4, 4, v1
    v_mul_u32_u24 v4, 65536, v4
    v_and_b32 v5, 15, v1
    v_lshlrev_b32 v5, 4, v5
    v_add_u32 v18, v4, v5
    s_lshl_b32 s90, s3, 19
    s_lshl_b32 s91, s81, 8
    s_add_u32 s90, s90, s91
    buffer_load_dwordx4 v[32:35], v7, s[44:47], 0 offen
    buffer_load_ushort v17, v2, s[44:47], 0 offen
    buffer_load_ushort v16, v2, s[48:51], 0 offen
    buffer_load_dwordx4 v[192:195], v18, s[56:59], s90 offen offset:0 nt
    s_add_u32 s93, s90, 8192
    buffer_load_dwordx4 v[196:199], v18, s[56:59], s93 offen nt
    s_add_u32 s93, s90, 16384
    buffer_load_dwordx4 v[200:203], v18, s[56:59], s93 offen nt
    s_add_u32 s93, s90, 24576
    buffer_load_dwordx4 v[204:207], v18, s[56:59], s93 offen nt
    s_cmp_ge_u32 s3, 4
    s_cbranch_scc1 L_a1done_5
    s_waitcnt vmcnt(7)
    v_lshlrev_b32 v22, 16, v22
    v_mul_f32 v5, 0xbfb8aa3b, v22
    v_exp_f32 v5, v5
    s_nop 0
    v_add_f32 v5, 1.0, v5
    v_rcp_f32 v5, v5
    s_nop 0
    v_mul_f32 v22, v22, v5
    v_cvt_pk_bf16_f32 v22, v22, v22
    v_lshl_add_u32 v4, v1, 1, s82
    ds_write_b16 v4, v22
    v_and_b32 v5, 1, v1
    v_lshlrev_b32 v5, 6, v5
    v_lshrrev_b32 v6, 4, v1
    v_lshl_add_u32 v5, v6, 4, v5
    v_add_u32 v5, s82, v5
    ds_read_b128 v[8:11], v5
    v_perm_b32 v44, v100, v96, s94
    v_perm_b32 v48, v100, v96, s95
    v_perm_b32 v45, v108, v104, s94
    v_perm_b32 v49, v108, v104, s95
    v_perm_b32 v46, v116, v112, s94
    v_perm_b32 v50, v116, v112, s95
    v_perm_b32 v47, v124, v120, s94
    v_perm_b32 v51, v124, v120, s95
    v_perm_b32 v52, v101, v97, s94
    v_perm_b32 v56, v101, v97, s95
    v_perm_b32 v53, v109, v105, s94
    v_perm_b32 v57, v109, v105, s95
    v_perm_b32 v54, v117, v113, s94
    v_perm_b32 v58, v117, v113, s95
    v_perm_b32 v55, v125, v121, s94
    v_perm_b32 v59, v125, v121, s95
    v_perm_b32 v60, v102, v98, s94
    v_perm_b32 v64, v102, v98, s95
    v_perm_b32 v61, v110, v106, s94
    v_perm_b32 v65, v110, v106, s95
    v_perm_b32 v62, v118, v114, s94
    v_perm_b32 v66, v118, v114, s95
    v_perm_b32 v63, v126, v122, s94
    v_perm_b32 v67, v126, v122, s95
    v_perm_b32 v68, v103, v99, s94
    v_perm_b32 v72, v103, v99, s95
    v_perm_b32 v69, v111, v107, s94
    v_perm_b32 v73, v111, v107, s95
    v_perm_b32 v70, v119, v115, s94
    v_perm_b32 v74, v119, v115, s95
    v_perm_b32 v71, v127, v123, s94
    v_perm_b32 v75, v127, v123, s95
    s_waitcnt lgkmcnt(0)
    v_mfma_f32_16x16x32_bf16 v[128:131], v[8:11], v[44:47], 0
    v_mfma_f32_16x16x32_bf16 v[132:135], v[8:11], v[48:51], 0
    v_mfma_f32_16x16x32_bf16 v[136:139], v[8:11], v[52:55], 0
    v_mfma_f32_16x16x32_bf16 v[140:143], v[8:11], v[56:59], 0
    v_mfma_f32_16x16x32_bf16 v[144:147], v[8:11], v[60:63], 0
    v_mfma_f32_16x16x32_bf16 v[148:151], v[8:11], v[64:67], 0
    v_mfma_f32_16x16x32_bf16 v[152:155], v[8:11], v[68:71], 0
    v_mfma_f32_16x16x32_bf16 v[156:159], v[8:11], v[72:75], 0
    s_nop 0
    v_add_f32_dpp v76, v129, v128 row_shl:8 row_mask:0xf bank_mask:0xf
    v_add_f32_dpp v77, v133, v132 row_shl:8 row_mask:0xf bank_mask:0xf
    v_add_f32_dpp v78, v137, v136 row_shl:8 row_mask:0xf bank_mask:0xf
    v_add_f32_dpp v79, v141, v140 row_shl:8 row_mask:0xf bank_mask:0xf
    v_add_f32_dpp v80, v145, v144 row_shl:8 row_mask:0xf bank_mask:0xf
    v_add_f32_dpp v81, v149, v148 row_shl:8 row_mask:0xf bank_mask:0xf
    v_add_f32_dpp v82, v153, v152 row_shl:8 row_mask:0xf bank_mask:0xf
    v_add_f32_dpp v83, v157, v156 row_shl:8 row_mask:0xf bank_mask:0xf
    s_lshl_b32 s91, s3, 8
    v_lshlrev_b32 v4, 5, v1
    v_add_u32 v4, s91, v4
    s_mov_b64 exec, 0xff
    ds_write_b128 v4, v[76:79] offset:2304
    ds_write_b128 v4, v[80:83] offset:2320
    s_mov_b64 exec, 1
    v_mov_b32 v5, 1024
    v_mov_b32 v6, 1
    s_waitcnt lgkmcnt(0)
    ds_add_rtn_u32 v7, v5, v6
    s_waitcnt lgkmcnt(0)
    v_readfirstlane_b32 s91, v7
    s_mov_b64 exec, -1
    s_cmp_lg_u32 s91, 3
    s_cbranch_scc1 L_a1done_5
    v_lshlrev_b32 v4, 2, v1
    ds_read_b32 v76, v4 offset:2304
    ds_read_b32 v77, v4 offset:2560
    ds_read_b32 v78, v4 offset:2816
    ds_read_b32 v79, v4 offset:3072
    s_waitcnt lgkmcnt(0)
    s_and_b32 s100, s100, 0x7f
    s_add_u32 s100, s100, 1
    v_add_f32 v76, v76, v77
    v_add_f32 v78, v78, v79
    v_add_f32 v76, v76, v78
    v_mov_b32_sdwa v76, s100 dst_sel:BYTE_0 dst_unused:UNUSED_PRESERVE src0_sel:DWORD
    s_nop 0
    buffer_store_dword v76, v4, s[36:39], s88 offen sc1
    s_sub_u32 s100, s100, 1
L_a1done_5:
    s_waitcnt vmcnt(6)
    s_add_u32 s93, s90, 32768
    buffer_load_dwordx4 v[208:211], v18, s[56:59], s93 offen nt
    s_waitcnt vmcnt(6)
    s_add_u32 s93, s90, 40960
    buffer_load_dwordx4 v[212:215], v18, s[56:59], s93 offen nt
    s_waitcnt vmcnt(6)
    s_add_u32 s93, s90, 49152
    buffer_load_dwordx4 v[216:219], v18, s[56:59], s93 offen nt
    s_waitcnt vmcnt(6)
    s_add_u32 s93, s90, 57344
    buffer_load_dwordx4 v[220:223], v18, s[56:59], s93 offen nt
    s_mov_b32 s40, s32
    s_mov_b32 s41, s33
    s_mov_b32 s42, 256
    s_mov_b32 s43, 0x20000
    s_mov_b32 s4, s16
    s_mov_b32 s5, s17
    s_mov_b32 s6, 4194304
    s_mov_b32 s7, 0x20000
    s_mov_b32 s64, s20
    s_mov_b32 s65, s21
    s_mov_b32 s66, 1835008
    s_mov_b32 s67, 0x20000
    s_mov_b32 s68, s22
    s_mov_b32 s69, s23
    s_mov_b32 s70, 1835008
    s_mov_b32 s71, 0x20000
    s_mov_b32 s72, s24
    s_mov_b32 s73, s25
    s_mov_b32 s74, 1835008
    s_mov_b32 s75, 0x20000
    s_mov_b32 s84, s30
    s_mov_b32 s85, s31
    s_mov_b32 s86, 1024
    s_mov_b32 s87, 0x20000
    s_waitcnt lgkmcnt(0)
    s_and_b32 s100, s100, 0x7f
    s_add_u32 s100, s100, 1
    s_cmp_lg_u32 s3, 0
    s_cbranch_scc1 L_xcc_6
    s_getreg_b32 s91, hwreg(HW_REG_XCC_ID)
    s_and_b32 s91, s91, 15
    s_add_u32 s91, s91, 1
    v_mov_b32 v5, s91
    s_lshl_b32 s92, s81, 2
    v_mov_b32 v6, s92
    s_mov_b64 exec, 1
    buffer_store_dword v5, v6, s[40:43], 0 offen offset:0 sc1
    s_mov_b64 exec, -1
L_xcc_6:
    v_lshlrev_b32 v36, 16, v32
    v_and_b32 v37, 0xffff0000, v32
    v_lshlrev_b32 v38, 16, v33
    v_and_b32 v39, 0xffff0000, v33
    v_lshlrev_b32 v40, 16, v34
    v_and_b32 v41, 0xffff0000, v34
    v_lshlrev_b32 v42, 16, v35
    v_and_b32 v43, 0xffff0000, v35
    v_add_f32 v8, v36, v37
    v_mul_f32 v9, v36, v36
    v_fmac_f32 v9, v37, v37
    v_add_f32 v8, v8, v38
    v_fmac_f32 v9, v38, v38
    v_add_f32 v8, v8, v39
    v_fmac_f32 v9, v39, v39
    v_add_f32 v8, v8, v40
    v_fmac_f32 v9, v40, v40
    v_add_f32 v8, v8, v41
    v_fmac_f32 v9, v41, v41
    v_add_f32 v8, v8, v42
    v_fmac_f32 v9, v42, v42
    v_add_f32 v8, v8, v43
    v_fmac_f32 v9, v43, v43
    s_nop 1
    v_permlane32_swap_b32 v8, v9
    v_add_f32 v8, v8, v9
    v_mov_b32 v4, v8
    s_nop 1
    v_permlane16_swap_b32 v8, v4
    v_add_f32 v8, v8, v4
    s_nop 1
    v_add_f32_dpp v8, v8, v8 row_ror:1 row_mask:0xf bank_mask:0xf
    s_nop 1
    v_add_f32_dpp v8, v8, v8 row_ror:2 row_mask:0xf bank_mask:0xf
    s_nop 1
    v_add_f32_dpp v8, v8, v8 row_ror:4 row_mask:0xf bank_mask:0xf
    s_nop 1
    v_add_f32_dpp v8, v8, v8 row_ror:8 row_mask:0xf bank_mask:0xf
    v_lshlrev_b32 v16, 16, v16
    v_lshlrev_b32 v17, 16, v17
    v_readlane_b32 s91, v8, 0
    v_readlane_b32 s92, v8, 32
    v_mul_f32 v4, 0xbfb8aa3b, v16
    v_exp_f32 v4, v4
    s_nop 0
    v_add_f32 v4, 1.0, v4
    v_rcp_f32 v4, v4
    s_nop 0
    v_mul_f32 v16, v16, v4
    v_mov_b32 v4, 0x3b000000
    v_mul_f32 v5, s91, v4
    v_mul_f32 v6, s92, v4
    v_fma_f32 v6, -v5, v5, v6
    v_add_f32 v6, 0x3727c5ac, v6
    v_rsq_f32 v6, v6
    v_sub_f32 v3, v17, v5
    v_mul_f32 v3, v3, v6
    v_cvt_pk_bf16_f32 v16, v16, v16
    v_lshl_add_u32 v4, v1, 1, s82
    ds_write_b16 v4, v16 offset:128
    s_waitcnt vmcnt(6)
    s_add_u32 s93, s90, 262144
    buffer_load_dwordx4 v[224:227], v18, s[56:59], s93 offen nt
    s_waitcnt vmcnt(6)
    s_add_u32 s93, s90, 270336
    buffer_load_dwordx4 v[228:231], v18, s[56:59], s93 offen nt
    s_waitcnt vmcnt(6)
    s_add_u32 s93, s90, 278528
    buffer_load_dwordx4 v[232:235], v18, s[56:59], s93 offen nt
    s_waitcnt vmcnt(6)
    s_add_u32 s93, s90, 286720
    buffer_load_dwordx4 v[236:239], v18, s[56:59], s93 offen nt
    s_waitcnt vmcnt(6)
    s_add_u32 s93, s90, 294912
    buffer_load_dwordx4 v[240:243], v18, s[56:59], s93 offen nt
    s_waitcnt vmcnt(6)
    s_add_u32 s93, s90, 303104
    buffer_load_dwordx4 v[244:247], v18, s[56:59], s93 offen nt
    s_waitcnt vmcnt(6)
    s_add_u32 s93, s90, 311296
    buffer_load_dwordx4 v[248:251], v18, s[56:59], s93 offen nt
    s_waitcnt vmcnt(6)
    s_add_u32 s93, s90, 319488
    buffer_load_dwordx4 v[252:255], v18, s[56:59], s93 offen nt
    v_lshlrev_b32 v20, 1, v2
    s_mov_b32 s89, 4096
    s_waitcnt vmcnt(3)
    buffer_load_dword v76, v20, s[36:39], 0 offen offset:0 sc1
    buffer_load_dword v77, v20, s[36:39], s89 offen offset:0 sc1
    buffer_load_dword v78, v20, s[36:39], 0 offen offset:2048 sc1
    buffer_load_dword v79, v20, s[36:39], s89 offen offset:2048 sc1
    v_lshrrev_b32 v4, 4, v1
    v_lshlrev_b32 v4, 3, v4
    v_bfe_u32 v5, v1, 3, 1
    v_lshlrev_b32 v5, 5, v5
    v_add_u32 v4, v4, v5
    v_mul_u32_u24 v4, 6144, v4
    v_and_b32 v5, 7, v1
    v_lshlrev_b32 v5, 4, v5
    v_add_u32 v19, v4, v5
    v_lshrrev_b32 v4, 4, v1
    v_lshlrev_b32 v4, 3, v4
    v_bfe_u32 v5, v1, 3, 1
    v_lshlrev_b32 v5, 5, v5
    v_add_u32 v4, v4, v5
    v_mul_u32_u24 v4, 3584, v4
    v_and_b32 v5, 7, v1
    v_lshlrev_b32 v5, 4, v5
    v_add_u32 v21, v4, v5
    v_lshrrev_b32 v4, 4, v1
    v_lshlrev_b32 v4, 3, v4
    v_bfe_u32 v5, v1, 3, 1
    v_lshlrev_b32 v5, 5, v5
    v_add_u32 v4, v4, v5
    v_mul_u32_u24 v4, 1024, v4
    v_and_b32 v5, 7, v1
    v_lshlrev_b32 v5, 4, v5
    v_add_u32 v23, v4, v5
    v_lshrrev_b32 v4, 4, v1
    v_mul_u32_u24 v4, 8192, v4
    v_and_b32 v5, 15, v1
    v_lshlrev_b32 v5, 4, v5
    v_add_u32 v24, v4, v5
    s_mul_i32 s90, s3, 393216
    s_lshl_b32 s91, s81, 7
    s_add_u32 s90, s90, s91
    s_add_u32 s90, s90, 2048
    s_mul_i32 s61, s3, 229376
    s_add_u32 s61, s61, s91
    s_lshl_b32 s62, s81, 16
    s_lshl_b32 s91, s3, 7
    s_add_u32 s62, s62, s91
    s_cmp_lt_u32 s81, 28
    s_cselect_b32 s61, s61, 268435456
    s_cselect_b32 s62, s62, 268435456
    s_lshr_b32 s60, s81, 1
    s_lshl_b32 s10, s60, 8
    s_lshl_b32 s63, s3, 5
    s_add_u32 s10, s10, s63
    s_lshl_b32 s10, s10, 10
    s_and_b32 s11, s81, 1
    s_lshl_b32 s63, s11, 9
    s_add_u32 s10, s10, s63
    s_mul_i32 s63, s3, 16384
    s_add_u32 s63, s63, 28928
    v_perm_b32 v160, v196, v192, s94
    v_perm_b32 v164, v196, v192, s95
    v_perm_b32 v161, v204, v200, s94
    v_perm_b32 v165, v204, v200, s95
    v_perm_b32 v162, v212, v208, s94
    v_perm_b32 v166, v212, v208, s95
    v_perm_b32 v163, v220, v216, s94
    v_perm_b32 v167, v220, v216, s95
    v_perm_b32 v168, v197, v193, s94
    v_perm_b32 v172, v197, v193, s95
    v_perm_b32 v169, v205, v201, s94
    v_perm_b32 v173, v205, v201, s95
    v_perm_b32 v170, v213, v209, s94
    v_perm_b32 v174, v213, v209, s95
    v_perm_b32 v171, v221, v217, s94
    v_perm_b32 v175, v221, v217, s95
    v_perm_b32 v176, v198, v194, s94
    v_perm_b32 v180, v198, v194, s95
    v_perm_b32 v177, v206, v202, s94
    v_perm_b32 v181, v206, v202, s95
    v_perm_b32 v178, v214, v210, s94
    v_perm_b32 v182, v214, v210, s95
    v_perm_b32 v179, v222, v218, s94
    v_perm_b32 v183, v222, v218, s95
    v_perm_b32 v184, v199, v195, s94
    v_perm_b32 v188, v199, v195, s95
    v_perm_b32 v185, v207, v203, s94
    v_perm_b32 v189, v207, v203, s95
    v_perm_b32 v186, v215, v211, s94
    v_perm_b32 v190, v215, v211, s95
    v_perm_b32 v187, v223, v219, s94
    v_perm_b32 v191, v223, v219, s95
    s_waitcnt vmcnt(6)
    buffer_load_dwordx4 v[128:131], v19, s[52:55], s90 offen offset:0 nt
    s_waitcnt vmcnt(6)
    s_add_u32 s93, s90, 6144
    buffer_load_dwordx4 v[132:135], v19, s[52:55], s93 offen nt
    s_waitcnt vmcnt(6)
    s_add_u32 s93, s90, 12288
    buffer_load_dwordx4 v[136:139], v19, s[52:55], s93 offen nt
    v_perm_b32 v192, v228, v224, s94
    v_perm_b32 v196, v228, v224, s95
    v_perm_b32 v193, v236, v232, s94
    v_perm_b32 v197, v236, v232, s95
    v_perm_b32 v194, v244, v240, s94
    v_perm_b32 v198, v244, v240, s95
    v_perm_b32 v195, v252, v248, s94
    v_perm_b32 v199, v252, v248, s95
    v_perm_b32 v200, v229, v225, s94
    v_perm_b32 v204, v229, v225, s95
    v_perm_b32 v201, v237, v233, s94
    v_perm_b32 v205, v237, v233, s95
    v_perm_b32 v202, v245, v241, s94
    v_perm_b32 v206, v245, v241, s95
    v_perm_b32 v203, v253, v249, s94
    v_perm_b32 v207, v253, v249, s95
    v_perm_b32 v208, v230, v226, s94
    v_perm_b32 v212, v230, v226, s95
    v_perm_b32 v209, v238, v234, s94
    v_perm_b32 v213, v238, v234, s95
    v_perm_b32 v210, v246, v242, s94
    v_perm_b32 v214, v246, v242, s95
    v_perm_b32 v211, v254, v250, s94
    v_perm_b32 v215, v254, v250, s95
    v_perm_b32 v216, v231, v227, s94
    v_perm_b32 v220, v231, v227, s95
    v_perm_b32 v217, v239, v235, s94
    v_perm_b32 v221, v239, v235, s95
    v_perm_b32 v218, v247, v243, s94
    v_perm_b32 v222, v247, v243, s95
    v_perm_b32 v219, v255, v251, s94
    v_perm_b32 v223, v255, v251, s95
    s_waitcnt vmcnt(3)
    v_msad_u8 v5, v76, s100, 0
    v_msad_u8 v5, v77, s100, v5
    v_msad_u8 v5, v78, s100, v5
    v_msad_u8 v5, v79, s100, v5
    v_cmp_ne_u32 vcc, 0, v5
    s_cbranch_vccz L_modaok_8
L_moda_7:
    s_sleep 2
    buffer_load_dword v76, v20, s[36:39], 0 offen offset:0 sc1
    buffer_load_dword v77, v20, s[36:39], s89 offen offset:0 sc1
    buffer_load_dword v78, v20, s[36:39], 0 offen offset:2048 sc1
    buffer_load_dword v79, v20, s[36:39], s89 offen offset:2048 sc1
    s_waitcnt vmcnt(0)
    v_msad_u8 v5, v76, s100, 0
    v_msad_u8 v5, v77, s100, v5
    v_msad_u8 v5, v78, s100, v5
    v_msad_u8 v5, v79, s100, v5
    v_cmp_ne_u32 vcc, 0, v5
    s_cbranch_vccz L_modaok_8
    s_sub_u32 s99, s99, 1
    s_cmp_gt_i32 s99, 0
    s_cbranch_scc1 L_moda_7
L_modaok_8:
    v_add_f32 v76, v76, v77
    v_add_f32 v78, v78, v79
    v_add_f32 v78, 1.0, v78
    v_fma_f32 v76, v3, v78, v76
    v_cvt_pk_bf16_f32 v76, v76, v76
    v_lshl_add_u32 v4, v1, 1, s82
    ds_write_b16 v4, v76
    v_lshrrev_b32 v4, 4, v1
    v_lshl_add_u32 v4, v4, 4, s82
    ds_read_b128 v[8:11], v4
    ds_read_b128 v[12:15], v4 offset:64
    s_waitcnt lgkmcnt(0)
    v_mfma_f32_16x16x32_bf16 v[44:47], v[8:11], v[160:163], 0
    v_mfma_f32_16x16x32_bf16 v[48:51], v[8:11], v[164:167], 0
    v_mfma_f32_16x16x32_bf16 v[52:55], v[8:11], v[168:171], 0
    v_mfma_f32_16x16x32_bf16 v[56:59], v[8:11], v[172:175], 0
    v_mfma_f32_16x16x32_bf16 v[60:63], v[8:11], v[176:179], 0
    v_mfma_f32_16x16x32_bf16 v[64:67], v[8:11], v[180:183], 0
    v_mfma_f32_16x16x32_bf16 v[68:71], v[8:11], v[184:187], 0
    v_mfma_f32_16x16x32_bf16 v[72:75], v[8:11], v[188:191], 0
    v_mfma_f32_16x16x32_bf16 v[44:47], v[12:15], v[192:195], v[44:47]
    v_mfma_f32_16x16x32_bf16 v[48:51], v[12:15], v[196:199], v[48:51]
    v_mfma_f32_16x16x32_bf16 v[52:55], v[12:15], v[200:203], v[52:55]
    v_mfma_f32_16x16x32_bf16 v[56:59], v[12:15], v[204:207], v[56:59]
    v_mfma_f32_16x16x32_bf16 v[60:63], v[12:15], v[208:211], v[60:63]
    v_mfma_f32_16x16x32_bf16 v[64:67], v[12:15], v[212:215], v[64:67]
    v_mfma_f32_16x16x32_bf16 v[68:71], v[12:15], v[216:219], v[68:71]
    v_mfma_f32_16x16x32_bf16 v[72:75], v[12:15], v[220:223], v[72:75]
    s_add_u32 s93, s90, 18432
    buffer_load_dwordx4 v[140:143], v19, s[52:55], s93 offen nt
    s_add_u32 s93, s90, 24576
    buffer_load_dwordx4 v[144:147], v19, s[52:55], s93 offen nt
    s_add_u32 s93, s90, 30720
    buffer_load_dwordx4 v[148:151], v19, s[52:55], s93 offen nt
    s_lshl_b32 s91, s3, 9
    s_add_u32 s91, s91, 4352
    v_lshlrev_b32 v4, 5, v1
    v_add_u32 v4, s91, v4
    s_mov_b64 exec, 0xffff
    ds_write2_b32 v4, v44, v48 offset0:0 offset1:1
    ds_write2_b32 v4, v52, v56 offset0:2 offset1:3
    ds_write2_b32 v4, v60, v64 offset0:4 offset1:5
    ds_write2_b32 v4, v68, v72 offset0:6 offset1:7
    s_mov_b64 exec, 1
    v_mov_b32 v5, 1028
    v_mov_b32 v6, 1
    s_waitcnt lgkmcnt(0)
    ds_add_rtn_u32 v7, v5, v6
    s_waitcnt lgkmcnt(0)
    v_readfirstlane_b32 s91, v7
    s_mov_b64 exec, -1
    s_cmp_lg_u32 s91, 7
    s_cbranch_scc1 L_qpub_9
    v_lshlrev_b32 v4, 3, v1
    ds_read_b64 v[76:77], v4 offset:4352
    ds_read_b64 v[78:79], v4 offset:4864
    ds_read_b64 v[80:81], v4 offset:5376
    ds_read_b64 v[82:83], v4 offset:5888
    ds_read_b64 v[84:85], v4 offset:6400
    ds_read_b64 v[86:87], v4 offset:6912
    ds_read_b64 v[88:89], v4 offset:7424
    ds_read_b64 v[90:91], v4 offset:7936
    s_waitcnt lgkmcnt(0)
    v_add_f32 v76, v76, v78
    v_add_f32 v77, v77, v79
    v_add_f32 v76, v76, v80
    v_add_f32 v77, v77, v81
    v_add_f32 v76, v76, v82
    v_add_f32 v77, v77, v83
    v_add_f32 v76, v76, v84
    v_add_f32 v77, v77, v85
    v_add_f32 v76, v76, v86
    v_add_f32 v77, v77, v87
    v_add_f32 v76, v76, v88
    v_add_f32 v77, v77, v89
    v_add_f32 v76, v76, v90
    v_add_f32 v77, v77, v91
    v_mov_b32_sdwa v76, s100 dst_sel:BYTE_0 dst_unused:UNUSED_PRESERVE src0_sel:DWORD
    v_mov_b32_sdwa v77, s100 dst_sel:BYTE_0 dst_unused:UNUSED_PRESERVE src0_sel:DWORD
    s_lshl_b32 s91, s81, 9
    s_add_u32 s91, s91, 16384
    buffer_store_dwordx2 v[76:77], v4, s[36:39], s91 offen sc1
L_qpub_9:
    v_lshrrev_b32 v4, 4, v1
    v_and_b32 v5, 1, v4
    v_lshlrev_b32 v5, 1, v5
    v_lshrrev_b32 v6, 1, v4
    v_or_b32 v6, v6, v5
    s_lshl_b32 s16, s3, 9
    s_add_u32 s16, s16, 24832
    v_lshlrev_b32 v26, 4, v4
    v_add_u32 v26, s16, v26
    v_and_b32 v25, 1, v1
    v_lshlrev_b32 v25, 6, v25
    v_add3_u32 v25, v25, v26, 0
    v_and_b32 v5, 7, v1
    v_lshl_add_u32 v5, v5, 2, v6
    v_lshlrev_b32 v5, 1, v5
    v_add_u32 v12, s16, v5
    v_and_b32 v5, 15, v1
    v_lshl_add_u32 v5, v5, 2, v6
    v_lshlrev_b32 v7, 1, v5
    v_add_u32 v13, s16, v7
    s_lshl_b32 s91, s3, 6
    v_add_u32 v5, s91, v5
    v_lshlrev_b32 v14, 2, v5
    v_lshlrev_b32 v7, 1, v5
    v_and_b32 v5, 3, v1
    v_lshl_add_u32 v5, v5, 2, v6
    s_lshl_b32 s91, s81, 4
    v_add_u32 v5, s91, v5
    v_lshlrev_b32 v15, 2, v5
    v_lshlrev_b32 v5, 1, v5
    v_and_b32 v4, 12, v1
    v_cmp_eq_u32 vcc, 0, v4
    v_mov_b32 v27, 268435456
    s_nop 0
    v_cndmask_b32 v27, v27, v5, vcc
    s_mov_b32 s8, 8192
    s_mov_b32 s9, 12288
    v_mov_b32 v2, v7
    v_and_b32 v92, 31, v1
    v_lshlrev_b32 v92, 2, v92
    s_add_u32 s93, s90, 36864
    buffer_load_dwordx4 v[152:155], v19, s[52:55], s93 offen nt
    s_waitcnt vmcnt(6)
    s_add_u32 s93, s90, 43008
    buffer_load_dwordx4 v[156:159], v19, s[52:55], s93 offen nt
    s_waitcnt vmcnt(6)
    buffer_load_dwordx4 v[160:163], v24, s[4:7], s10 offen offset:0 nt
    s_waitcnt vmcnt(6)
    buffer_load_dwordx4 v[192:195], v24, s[4:7], s10 offen offset:256 nt
    s_waitcnt vmcnt(6)
    buffer_load_dwordx4 v[164:167], v24, s[4:7], s10 offen offset:1024 nt
    s_waitcnt vmcnt(6)
    buffer_load_dwordx4 v[196:199], v24, s[4:7], s10 offen offset:1280 nt
    s_waitcnt vmcnt(6)
    buffer_load_dwordx4 v[168:171], v24, s[4:7], s10 offen offset:2048 nt
    s_waitcnt vmcnt(6)
    buffer_load_dwordx4 v[200:203], v24, s[4:7], s10 offen offset:2304 nt
    s_waitcnt vmcnt(6)
    buffer_load_dwordx4 v[172:175], v24, s[4:7], s10 offen offset:3072 nt
    v_perm_b32 v96, v132, v128, s94
    v_perm_b32 v100, v132, v128, s95
    v_perm_b32 v97, v140, v136, s94
    v_perm_b32 v101, v140, v136, s95
    v_perm_b32 v98, v148, v144, s94
    v_perm_b32 v102, v148, v144, s95
    v_perm_b32 v99, v156, v152, s94
    v_perm_b32 v103, v156, v152, s95
    v_perm_b32 v104, v133, v129, s94
    v_perm_b32 v108, v133, v129, s95
    v_perm_b32 v105, v141, v137, s94
    v_perm_b32 v109, v141, v137, s95
    v_perm_b32 v106, v149, v145, s94
    v_perm_b32 v110, v149, v145, s95
    v_perm_b32 v107, v157, v153, s94
    v_perm_b32 v111, v157, v153, s95
    v_perm_b32 v112, v134, v130, s94
    v_perm_b32 v116, v134, v130, s95
    v_perm_b32 v113, v142, v138, s94
    v_perm_b32 v117, v142, v138, s95
    v_perm_b32 v114, v150, v146, s94
    v_perm_b32 v118, v150, v146, s95
    v_perm_b32 v115, v158, v154, s94
    v_perm_b32 v119, v158, v154, s95
    v_perm_b32 v120, v135, v131, s94
    v_perm_b32 v124, v135, v131, s95
    v_perm_b32 v121, v143, v139, s94
    v_perm_b32 v125, v143, v139, s95
    v_perm_b32 v122, v151, v147, s94
    v_perm_b32 v126, v151, v147, s95
    v_perm_b32 v123, v159, v155, s94
    v_perm_b32 v127, v159, v155, s95
    ds_read_b128 v[8:11], v25 offset:128
    s_waitcnt lgkmcnt(0)
    v_mfma_f32_16x16x32_bf16 v[44:47], v[8:11], v[96:99], 0
    v_mfma_f32_16x16x32_bf16 v[48:51], v[8:11], v[100:103], 0
    v_mfma_f32_16x16x32_bf16 v[52:55], v[8:11], v[104:107], 0
    v_mfma_f32_16x16x32_bf16 v[56:59], v[8:11], v[108:111], 0
    v_mfma_f32_16x16x32_bf16 v[60:63], v[8:11], v[112:115], 0
    v_mfma_f32_16x16x32_bf16 v[64:67], v[8:11], v[116:119], 0
    v_mfma_f32_16x16x32_bf16 v[68:71], v[8:11], v[120:123], 0
    v_mfma_f32_16x16x32_bf16 v[72:75], v[8:11], v[124:127], 0
    s_waitcnt vmcnt(6)
    buffer_load_dwordx4 v[204:207], v24, s[4:7], s10 offen offset:3328 nt
    s_waitcnt vmcnt(6)
    s_add_u32 s93, s10, 4096
    buffer_load_dwordx4 v[176:179], v24, s[4:7], s93 offen nt
    s_waitcnt vmcnt(6)
    s_add_u32 s93, s10, 4352
    buffer_load_dwordx4 v[208:211], v24, s[4:7], s93 offen nt
    s_waitcnt vmcnt(6)
    s_add_u32 s93, s10, 5120
    buffer_load_dwordx4 v[180:183], v24, s[4:7], s93 offen nt
    v_add_f32_dpp v76, v45, v44 row_shl:8 row_mask:0xf bank_mask:0xf
    v_add_f32_dpp v77, v49, v48 row_shl:8 row_mask:0xf bank_mask:0xf
    v_add_f32_dpp v78, v53, v52 row_shl:8 row_mask:0xf bank_mask:0xf
    v_add_f32_dpp v79, v57, v56 row_shl:8 row_mask:0xf bank_mask:0xf
    v_add_f32_dpp v80, v61, v60 row_shl:8 row_mask:0xf bank_mask:0xf
    v_add_f32_dpp v81, v65, v64 row_shl:8 row_mask:0xf bank_mask:0xf
    v_add_f32_dpp v82, v69, v68 row_shl:8 row_mask:0xf bank_mask:0xf
    v_add_f32_dpp v83, v73, v72 row_shl:8 row_mask:0xf bank_mask:0xf
    s_lshl_b32 s91, s3, 8
    v_lshlrev_b32 v4, 5, v1
    v_add_u32 v4, s91, v4
    s_mov_b64 exec, 0xff
    ds_write_b128 v4, v[76:79] offset:8448
    ds_write_b128 v4, v[80:83] offset:8464
    s_mov_b64 exec, 1
    v_mov_b32 v5, 1032
    v_mov_b32 v6, 1
    s_waitcnt lgkmcnt(0)
    ds_add_rtn_u32 v7, v5, v6
    s_waitcnt lgkmcnt(0)
    v_readfirstlane_b32 s91, v7
    s_mov_b64 exec, -1
    s_cmp_lg_u32 s91, 7
    s_cbranch_scc1 L_bpub_10
    v_lshlrev_b32 v4, 2, v1
    ds_read_b32 v76, v4 offset:8448
    ds_read_b32 v77, v4 offset:8704
    ds_read_b32 v78, v4 offset:8960
    ds_read_b32 v79, v4 offset:9216
    ds_read_b32 v80, v4 offset:9472
    ds_read_b32 v81, v4 offset:9728
    ds_read_b32 v82, v4 offset:9984
    ds_read_b32 v83, v4 offset:10240
    s_waitcnt lgkmcnt(0)
    v_add_f32 v76, v76, v77
    v_add_f32 v76, v76, v78
    v_add_f32 v76, v76, v79
    v_add_f32 v76, v76, v80
    v_add_f32 v76, v76, v81
    v_add_f32 v76, v76, v82
    v_add_f32 v76, v76, v83
    v_mov_b32_sdwa v76, s100 dst_sel:BYTE_0 dst_unused:UNUSED_PRESERVE src0_sel:DWORD
    s_lshl_b32 s91, s81, 8
    s_add_u32 s91, s91, 8192
    buffer_store_dword v76, v4, s[36:39], s91 offen sc1
L_bpub_10:
    s_waitcnt vmcnt(6)
    s_add_u32 s93, s10, 5376
    buffer_load_dwordx4 v[212:215], v24, s[4:7], s93 offen nt
    s_waitcnt vmcnt(6)
    s_add_u32 s93, s10, 6144
    buffer_load_dwordx4 v[184:187], v24, s[4:7], s93 offen nt
    s_waitcnt vmcnt(6)
    s_add_u32 s93, s10, 6400
    buffer_load_dwordx4 v[216:219], v24, s[4:7], s93 offen nt
    s_waitcnt vmcnt(6)
    s_add_u32 s93, s10, 7168
    buffer_load_dwordx4 v[188:191], v24, s[4:7], s93 offen nt
    s_waitcnt vmcnt(6)
    s_add_u32 s93, s10, 7424
    buffer_load_dwordx4 v[220:223], v24, s[4:7], s93 offen nt
    s_waitcnt vmcnt(6)
    buffer_load_dwordx4 v[224:227], v21, s[64:67], s61 offen offset:0 nt
    s_waitcnt vmcnt(6)
    buffer_load_dwordx4 v[228:231], v21, s[64:67], s61 offen offset:3584 nt
    s_waitcnt vmcnt(6)
    s_add_u32 s93, s61, 7168
    buffer_load_dwordx4 v[232:235], v21, s[64:67], s93 offen nt
    s_waitcnt vmcnt(6)
    s_add_u32 s93, s61, 10752
    buffer_load_dwordx4 v[236:239], v21, s[64:67], s93 offen nt
    s_waitcnt vmcnt(6)
    s_add_u32 s93, s61, 14336
    buffer_load_dwordx4 v[240:243], v21, s[64:67], s93 offen nt
    s_waitcnt vmcnt(6)
    s_add_u32 s93, s61, 17920
    buffer_load_dwordx4 v[244:247], v21, s[64:67], s93 offen nt
    s_waitcnt vmcnt(6)
    s_add_u32 s93, s61, 21504
    buffer_load_dwordx4 v[248:251], v21, s[64:67], s93 offen nt
    v_perm_b32 v96, v164, v160, s94
    v_perm_b32 v100, v164, v160, s95
    v_perm_b32 v97, v172, v168, s94
    v_perm_b32 v101, v172, v168, s95
    v_perm_b32 v98, v180, v176, s94
    v_perm_b32 v102, v180, v176, s95
    v_perm_b32 v99, v188, v184, s94
    v_perm_b32 v103, v188, v184, s95
    v_perm_b32 v104, v165, v161, s94
    v_perm_b32 v108, v165, v161, s95
    v_perm_b32 v105, v173, v169, s94
    v_perm_b32 v109, v173, v169, s95
    v_perm_b32 v106, v181, v177, s94
    v_perm_b32 v110, v181, v177, s95
    v_perm_b32 v107, v189, v185, s94
    v_perm_b32 v111, v189, v185, s95
    v_perm_b32 v112, v166, v162, s94
    v_perm_b32 v116, v166, v162, s95
    v_perm_b32 v113, v174, v170, s94
    v_perm_b32 v117, v174, v170, s95
    v_perm_b32 v114, v182, v178, s94
    v_perm_b32 v118, v182, v178, s95
    v_perm_b32 v115, v190, v186, s94
    v_perm_b32 v119, v190, v186, s95
    v_perm_b32 v120, v167, v163, s94
    v_perm_b32 v124, v167, v163, s95
    v_perm_b32 v121, v175, v171, s94
    v_perm_b32 v125, v175, v171, s95
    v_perm_b32 v122, v183, v179, s94
    v_perm_b32 v126, v183, v179, s95
    v_perm_b32 v123, v191, v187, s94
    v_perm_b32 v127, v191, v187, s95
    v_perm_b32 v128, v196, v192, s94
    v_perm_b32 v132, v196, v192, s95
    v_perm_b32 v129, v204, v200, s94
    v_perm_b32 v133, v204, v200, s95
    v_perm_b32 v130, v212, v208, s94
    v_perm_b32 v134, v212, v208, s95
    v_perm_b32 v131, v220, v216, s94
    v_perm_b32 v135, v220, v216, s95
    v_perm_b32 v136, v197, v193, s94
    v_perm_b32 v140, v197, v193, s95
    v_perm_b32 v137, v205, v201, s94
    v_perm_b32 v141, v205, v201, s95
    v_perm_b32 v138, v213, v209, s94
    v_perm_b32 v142, v213, v209, s95
    v_perm_b32 v139, v221, v217, s94
    v_perm_b32 v143, v221, v217, s95
    v_perm_b32 v144, v198, v194, s94
    v_perm_b32 v148, v198, v194, s95
    v_perm_b32 v145, v206, v202, s94
    v_perm_b32 v149, v206, v202, s95
    v_perm_b32 v146, v214, v210, s94
    v_perm_b32 v150, v214, v210, s95
    v_perm_b32 v147, v222, v218, s94
    v_perm_b32 v151, v222, v218, s95
    v_perm_b32 v152, v199, v195, s94
    v_perm_b32 v156, v199, v195, s95
    v_perm_b32 v153, v207, v203, s94
    v_perm_b32 v157, v207, v203, s95
    v_perm_b32 v154, v215, v211, s94
    v_perm_b32 v158, v215, v211, s95
    v_perm_b32 v155, v223, v219, s94
    v_perm_b32 v159, v223, v219, s95
    s_waitcnt vmcnt(6)
    s_add_u32 s93, s61, 25088
    buffer_load_dwordx4 v[252:255], v21, s[64:67], s93 offen nt
    s_waitcnt vmcnt(1)
    buffer_load_dword v16, v14, s[36:39], s8 offen sc1
    buffer_load_dword v18, v14, s[36:39], s8 offen offset:2048 sc1
    buffer_load_dword v17, v14, s[36:39], s9 offen sc1
    buffer_load_dword v20, v15, s[36:39], s9 offen offset:2048 sc1
    buffer_load_ushort v19, v2, s[44:47], 0 offen
    buffer_load_dword v3, v92, s[40:43], 0 offen offset:0 sc1
    s_waitcnt vmcnt(6)
    s_add_u32 s93, s61, 0
    s_add_u32 s92, s63, 0
    s_mov_b32 m0, s92
    s_nop 0
    buffer_load_dwordx4 v21, s[68:71], s93 offen nt lds
    s_waitcnt vmcnt(6)
    s_add_u32 s93, s61, 3584
    s_add_u32 s92, s63, 1024
    s_mov_b32 m0, s92
    s_nop 0
    buffer_load_dwordx4 v21, s[68:71], s93 offen nt lds
    s_waitcnt vmcnt(6)
    s_add_u32 s93, s61, 7168
    s_add_u32 s92, s63, 2048
    s_mov_b32 m0, s92
    s_nop 0
    buffer_load_dwordx4 v21, s[68:71], s93 offen nt lds
    s_waitcnt vmcnt(6)
    s_add_u32 s93, s61, 10752
    s_add_u32 s92, s63, 3072
    s_mov_b32 m0, s92
    s_nop 0
    buffer_load_dwordx4 v21, s[68:71], s93 offen nt lds
    s_waitcnt vmcnt(6)
    s_add_u32 s93, s61, 14336
    s_add_u32 s92, s63, 4096
    s_mov_b32 m0, s92
    s_nop 0
    buffer_load_dwordx4 v21, s[68:71], s93 offen nt lds
    s_waitcnt vmcnt(6)
    s_add_u32 s93, s61, 17920
    s_add_u32 s92, s63, 5120
    s_mov_b32 m0, s92
    s_nop 0
    buffer_load_dwordx4 v21, s[68:71], s93 offen nt lds
    v_perm_b32 v160, v228, v224, s94
    v_perm_b32 v164, v228, v224, s95
    v_perm_b32 v161, v236, v232, s94
    v_perm_b32 v165, v236, v232, s95
    v_perm_b32 v162, v244, v240, s94
    v_perm_b32 v166, v244, v240, s95
    v_perm_b32 v163, v252, v248, s94
    v_perm_b32 v167, v252, v248, s95
    v_perm_b32 v168, v229, v225, s94
    v_perm_b32 v172, v229, v225, s95
    v_perm_b32 v169, v237, v233, s94
    v_perm_b32 v173, v237, v233, s95
    v_perm_b32 v170, v245, v241, s94
    v_perm_b32 v174, v245, v241, s95
    v_perm_b32 v171, v253, v249, s94
    v_perm_b32 v175, v253, v249, s95
    v_perm_b32 v176, v230, v226, s94
    v_perm_b32 v180, v230, v226, s95
    v_perm_b32 v177, v238, v234, s94
    v_perm_b32 v181, v238, v234, s95
    v_perm_b32 v178, v246, v242, s94
    v_perm_b32 v182, v246, v242, s95
    v_perm_b32 v179, v254, v250, s94
    v_perm_b32 v183, v254, v250, s95
    v_perm_b32 v184, v231, v227, s94
    v_perm_b32 v188, v231, v227, s95
    v_perm_b32 v185, v239, v235, s94
    v_perm_b32 v189, v239, v235, s95
    v_perm_b32 v186, v247, v243, s94
    v_perm_b32 v190, v247, v243, s95
    v_perm_b32 v187, v255, v251, s94
    v_perm_b32 v191, v255, v251, s95
    s_waitcnt vmcnt(6)
    s_add_u32 s93, s61, 21504
    s_add_u32 s92, s63, 6144
    s_mov_b32 m0, s92
    s_nop 0
    buffer_load_dwordx4 v21, s[68:71], s93 offen nt lds
    s_waitcnt vmcnt(6)
    s_add_u32 s93, s61, 25088
    s_add_u32 s92, s63, 7168
    s_mov_b32 m0, s92
    s_nop 0
    buffer_load_dwordx4 v21, s[68:71], s93 offen nt lds
    s_waitcnt vmcnt(6)
    s_add_u32 s93, s62, 0
    s_add_u32 s92, s63, 8192
    s_mov_b32 m0, s92
    s_nop 0
    buffer_load_dwordx4 v23, s[72:75], s93 offen nt lds
    s_waitcnt vmcnt(6)
    s_add_u32 s93, s62, 1024
    s_add_u32 s92, s63, 9216
    s_mov_b32 m0, s92
    s_nop 0
    buffer_load_dwordx4 v23, s[72:75], s93 offen nt lds
    s_waitcnt vmcnt(6)
    s_add_u32 s93, s62, 2048
    s_add_u32 s92, s63, 10240
    s_mov_b32 m0, s92
    s_nop 0
    buffer_load_dwordx4 v23, s[72:75], s93 offen nt lds
    s_waitcnt vmcnt(6)
    s_add_u32 s93, s62, 3072
    s_add_u32 s92, s63, 11264
    s_mov_b32 m0, s92
    s_nop 0
    buffer_load_dwordx4 v23, s[72:75], s93 offen nt lds
    s_waitcnt vmcnt(6)
    s_add_u32 s93, s62, 4096
    s_add_u32 s92, s63, 12288
    s_mov_b32 m0, s92
    s_nop 0
    buffer_load_dwordx4 v23, s[72:75], s93 offen nt lds
    s_waitcnt vmcnt(6)
    s_add_u32 s93, s62, 5120
    s_add_u32 s92, s63, 13312
    s_mov_b32 m0, s92
    s_nop 0
    buffer_load_dwordx4 v23, s[72:75], s93 offen nt lds
    s_waitcnt vmcnt(6)
    s_add_u32 s93, s62, 6144
    s_add_u32 s92, s63, 14336
    s_mov_b32 m0, s92
    s_nop 0
    buffer_load_dwordx4 v23, s[72:75], s93 offen nt lds
    s_waitcnt vmcnt(6)
    s_add_u32 s93, s62, 7168
    s_add_u32 s92, s63, 15360
    s_mov_b32 m0, s92
    s_nop 0
    buffer_load_dwordx4 v23, s[72:75], s93 offen nt lds
    v_msad_u8 v4, v16, s100, 0
    v_msad_u8 v4, v18, s100, v4
    v_msad_u8 v4, v17, s100, v4
    v_msad_u8 v4, v20, s100, v4
    v_cmp_ne_u32 vcc, 0, v4
    v_cmp_eq_u32 s[82:83], 0, v3
    s_nop 0
    s_or_b64 vcc, vcc, s[82:83]
    s_cbranch_vccz L_modbok_12
L_modb_11:
    s_sleep 2
    buffer_load_dword v16, v14, s[36:39], s8 offen sc1
    buffer_load_dword v18, v14, s[36:39], s8 offen offset:2048 sc1
    buffer_load_dword v17, v14, s[36:39], s9 offen sc1
    buffer_load_dword v20, v15, s[36:39], s9 offen offset:2048 sc1
    buffer_load_ushort v19, v2, s[44:47], 0 offen
    buffer_load_dword v3, v92, s[40:43], 0 offen offset:0 sc1
    s_waitcnt vmcnt(0)
    v_msad_u8 v4, v16, s100, 0
    v_msad_u8 v4, v18, s100, v4
    v_msad_u8 v4, v17, s100, v4
    v_msad_u8 v4, v20, s100, v4
    v_cmp_ne_u32 vcc, 0, v4
    v_cmp_eq_u32 s[82:83], 0, v3
    s_nop 0
    s_or_b64 vcc, vcc, s[82:83]
    s_cbranch_vccz L_modbok_12
    s_sub_u32 s99, s99, 1
    s_cmp_gt_i32 s99, 0
    s_cbranch_scc1 L_modb_11
L_modbok_12:
    v_readfirstlane_b32 s91, v3
    s_nop 1
    v_cmp_ne_u32 vcc, s91, v3
    s_nop 1
    s_cmp_eq_u64 vcc, 0
    s_cselect_b32 s98, 1, 0
    v_add_f32 v17, 1.0, v17
    v_lshlrev_b32 v19, 16, v19
    s_mul_i32 s91, s3, 16384
    s_add_u32 s91, s91, 28928
    v_lshl_add_u32 v4, v1, 4, s91
    ds_read_b128 v[44:47], v4 offset:0
    ds_read_b128 v[48:51], v4 offset:1024
    ds_read_b128 v[52:55], v4 offset:2048
    ds_read_b128 v[56:59], v4 offset:3072
    ds_read_b128 v[60:63], v4 offset:4096
    ds_read_b128 v[64:67], v4 offset:5120
    ds_read_b128 v[68:71], v4 offset:6144
    ds_read_b128 v[72:75], v4 offset:7168
    s_waitcnt lgkmcnt(0)
    v_perm_b32 v192, v48, v44, s94
    v_perm_b32 v196, v48, v44, s95
    v_perm_b32 v193, v56, v52, s94
    v_perm_b32 v197, v56, v52, s95
    v_perm_b32 v194, v64, v60, s94
    v_perm_b32 v198, v64, v60, s95
    v_perm_b32 v195, v72, v68, s94
    v_perm_b32 v199, v72, v68, s95
    v_perm_b32 v200, v49, v45, s94
    v_perm_b32 v204, v49, v45, s95
    v_perm_b32 v201, v57, v53, s94
    v_perm_b32 v205, v57, v53, s95
    v_perm_b32 v202, v65, v61, s94
    v_perm_b32 v206, v65, v61, s95
    v_perm_b32 v203, v73, v69, s94
    v_perm_b32 v207, v73, v69, s95
    v_perm_b32 v208, v50, v46, s94
    v_perm_b32 v212, v50, v46, s95
    v_perm_b32 v209, v58, v54, s94
    v_perm_b32 v213, v58, v54, s95
    v_perm_b32 v210, v66, v62, s94
    v_perm_b32 v214, v66, v62, s95
    v_perm_b32 v211, v74, v70, s94
    v_perm_b32 v215, v74, v70, s95
    v_perm_b32 v216, v51, v47, s94
    v_perm_b32 v220, v51, v47, s95
    v_perm_b32 v217, v59, v55, s94
    v_perm_b32 v221, v59, v55, s95
    v_perm_b32 v218, v67, v63, s94
    v_perm_b32 v222, v67, v63, s95
    v_perm_b32 v219, v75, v71, s94
    v_perm_b32 v223, v75, v71, s95
    s_mov_b32 s61, s11
    s_lshr_b32 s62, s60, 1
    s_mul_i32 s62, s62, 112
    s_and_b32 s63, s60, 1
    s_lshl_b32 s63, s63, 1
    s_add_u32 s62, s62, s63
    s_lshr_b32 s63, s3, 2
    s_add_u32 s62, s62, s63
    s_lshr_b32 s88, s60, 1
    s_mul_i32 s88, s88, 3584
    s_and_b32 s63, s60, 1
    s_lshl_b32 s63, s63, 1
    s_lshr_b32 s89, s3, 2
    s_add_u32 s63, s63, s89
    s_lshl_b32 s63, s63, 4
    s_add_u32 s88, s88, s63
    s_add_u32 s88, s88, 122880
    s_lshl_b32 s62, s62, 9
    s_and_b32 s63, s3, 3
    s_lshl_b32 s63, s63, 7
    s_add_u32 s62, s62, s63
    s_add_u32 s62, s62, 151552
    s_add_u32 s63, s62, 16384
    s_add_u32 s89, s62, 32768
    s_add_u32 s90, s62, 49152
    v_lshrrev_b32 v4, 3, v1
    v_and_b32 v5, 7, v1
    v_lshlrev_b32 v5, 4, v5
    v_lshl_add_u32 v21, v4, 11, v5
    v_lshlrev_b32 v22, 7, v4
    v_lshrrev_b32 v4, 4, v1
    v_and_b32 v5, 15, v1
    v_lshlrev_b32 v5, 4, v5
    v_lshl_add_u32 v23, v4, 11, v5
    s_lshl_b32 s91, s3, 8
    v_add_u32 v23, s91, v23
    v_lshrrev_b32 v4, 2, v1
    v_and_b32 v5, 3, v1
    v_lshlrev_b32 v5, 4, v5
    s_lshl_b32 s91, s81, 6
    v_add_u32 v5, s91, v5
    v_lshl_add_u32 v24, v4, 11, v5
    s_lshl_b32 s8, s3, 10
    s_add_u32 s8, s8, 10496
    s_lshl_b32 s9, s60, 11
    s_lshl_b32 s91, s61, 10
    s_add_u32 s9, s9, s91
    s_add_u32 s9, s9, 32768
    s_lshl_b32 s10, s3, 3
    s_add_u32 s10, s10, 2176
    s_lshl_b32 s11, s3, 9
    s_add_u32 s11, s11, 18688
    s_lshl_b32 s12, s81, 11
    s_lshl_b32 s91, s3, 8
    s_add_u32 s12, s12, s91
    s_add_u32 s12, s12, 65536
    s_cmp_lt_u32 s81, 28
    s_cselect_b32 s12, s12, 268435456
    s_mov_b32 s13, 32768
    s_mov_b32 s17, 40960
    s_mov_b32 s18, 49152
    s_mov_b32 s19, 57344
    s_mov_b32 s14, 65536
    s_mov_b32 s15, 98304
    v_cvt_pk_bf16_f32 v4, v17, v17
    v_cvt_pk_bf16_f32 v5, v18, v18
    ds_write_b16 v13, v4 offset:64
    ds_write_b16 v13, v5 offset:192
    v_bfe_u32 v4, v1, 1, 1
    v_lshl_add_u32 v4, v4, 7, v25
    ds_read_b128 v[8:11], v4 offset:64
    s_waitcnt lgkmcnt(0)
    v_mfma_f32_16x16x32_bf16 v[32:35], v[8:11], v[160:163], 0
    v_mfma_f32_16x16x32_bf16 v[36:39], v[8:11], v[164:167], 0
    v_mfma_f32_16x16x32_bf16 v[40:43], v[8:11], v[168:171], 0
    v_mfma_f32_16x16x32_bf16 v[44:47], v[8:11], v[172:175], 0
    v_mfma_f32_16x16x32_bf16 v[48:51], v[8:11], v[176:179], 0
    v_mfma_f32_16x16x32_bf16 v[52:55], v[8:11], v[180:183], 0
    v_mfma_f32_16x16x32_bf16 v[56:59], v[8:11], v[184:187], 0
    v_mfma_f32_16x16x32_bf16 v[60:63], v[8:11], v[188:191], 0
    v_mfma_f32_16x16x32_bf16 v[64:67], v[8:11], v[192:195], 0
    v_mfma_f32_16x16x32_bf16 v[68:71], v[8:11], v[196:199], 0
    v_mfma_f32_16x16x32_bf16 v[72:75], v[8:11], v[200:203], 0
    v_mfma_f32_16x16x32_bf16 v[76:79], v[8:11], v[204:207], 0
    v_mfma_f32_16x16x32_bf16 v[80:83], v[8:11], v[208:211], 0
    v_mfma_f32_16x16x32_bf16 v[84:87], v[8:11], v[212:215], 0
    v_mfma_f32_16x16x32_bf16 v[88:91], v[8:11], v[216:219], 0
    v_mfma_f32_16x16x32_bf16 v[92:95], v[8:11], v[220:223], 0
    s_mul_i32 s91, s3, 16384
    s_add_u32 s91, s91, 28928
    v_lshl_add_u32 v4, v1, 5, s91
    v_add_f32_dpp v28, v33, v32 row_shl:8 row_mask:0xf bank_mask:0xf
    v_add_f32_dpp v29, v37, v36 row_shl:8 row_mask:0xf bank_mask:0xf
    v_add_f32_dpp v30, v41, v40 row_shl:8 row_mask:0xf bank_mask:0xf
    v_add_f32_dpp v31, v45, v44 row_shl:8 row_mask:0xf bank_mask:0xf
    s_mov_b64 exec, 0xff
    ds_write_b128 v4, v[28:31] offset:0
    s_mov_b64 exec, -1
    s_nop 1
    v_add_f32_dpp v28, v49, v48 row_shl:8 row_mask:0xf bank_mask:0xf
    v_add_f32_dpp v29, v53, v52 row_shl:8 row_mask:0xf bank_mask:0xf
    v_add_f32_dpp v30, v57, v56 row_shl:8 row_mask:0xf bank_mask:0xf
    v_add_f32_dpp v31, v61, v60 row_shl:8 row_mask:0xf bank_mask:0xf
    s_mov_b64 exec, 0xff
    ds_write_b128 v4, v[28:31] offset:16
    s_mov_b64 exec, -1
    s_nop 1
    v_add_f32_dpp v28, v35, v34 row_shl:8 row_mask:0xf bank_mask:0xf
    v_add_f32_dpp v29, v39, v38 row_shl:8 row_mask:0xf bank_mask:0xf
    v_add_f32_dpp v30, v43, v42 row_shl:8 row_mask:0xf bank_mask:0xf
    v_add_f32_dpp v31, v47, v46 row_shl:8 row_mask:0xf bank_mask:0xf
    s_mov_b64 exec, 0xff
    ds_write_b128 v4, v[28:31] offset:256
    s_mov_b64 exec, -1
    s_nop 1
    v_add_f32_dpp v28, v51, v50 row_shl:8 row_mask:0xf bank_mask:0xf
    v_add_f32_dpp v29, v55, v54 row_shl:8 row_mask:0xf bank_mask:0xf
    v_add_f32_dpp v30, v59, v58 row_shl:8 row_mask:0xf bank_mask:0xf
    v_add_f32_dpp v31, v63, v62 row_shl:8 row_mask:0xf bank_mask:0xf
    s_mov_b64 exec, 0xff
    ds_write_b128 v4, v[28:31] offset:272
    s_mov_b64 exec, -1
    s_nop 1
    v_add_f32_dpp v28, v65, v64 row_shl:8 row_mask:0xf bank_mask:0xf
    v_add_f32_dpp v29, v69, v68 row_shl:8 row_mask:0xf bank_mask:0xf
    v_add_f32_dpp v30, v73, v72 row_shl:8 row_mask:0xf bank_mask:0xf
    v_add_f32_dpp v31, v77, v76 row_shl:8 row_mask:0xf bank_mask:0xf
    s_mov_b64 exec, 0xff
    ds_write_b128 v4, v[28:31] offset:512
    s_mov_b64 exec, -1
    s_nop 1
    v_add_f32_dpp v28, v81, v80 row_shl:8 row_mask:0xf bank_mask:0xf
    v_add_f32_dpp v29, v85, v84 row_shl:8 row_mask:0xf bank_mask:0xf
    v_add_f32_dpp v30, v89, v88 row_shl:8 row_mask:0xf bank_mask:0xf
    v_add_f32_dpp v31, v93, v92 row_shl:8 row_mask:0xf bank_mask:0xf
    s_mov_b64 exec, 0xff
    ds_write_b128 v4, v[28:31] offset:528
    s_mov_b64 exec, -1
    s_nop 1
    v_add_f32_dpp v28, v67, v66 row_shl:8 row_mask:0xf bank_mask:0xf
    v_add_f32_dpp v29, v71, v70 row_shl:8 row_mask:0xf bank_mask:0xf
    v_add_f32_dpp v30, v75, v74 row_shl:8 row_mask:0xf bank_mask:0xf
    v_add_f32_dpp v31, v79, v78 row_shl:8 row_mask:0xf bank_mask:0xf
    s_mov_b64 exec, 0xff
    ds_write_b128 v4, v[28:31] offset:768
    s_mov_b64 exec, -1
    s_nop 1
    v_add_f32_dpp v28, v83, v82 row_shl:8 row_mask:0xf bank_mask:0xf
    v_add_f32_dpp v29, v87, v86 row_shl:8 row_mask:0xf bank_mask:0xf
    v_add_f32_dpp v30, v91, v90 row_shl:8 row_mask:0xf bank_mask:0xf
    v_add_f32_dpp v31, v95, v94 row_shl:8 row_mask:0xf bank_mask:0xf
    s_mov_b64 exec, 0xff
    ds_write_b128 v4, v[28:31] offset:784
    s_mov_b64 exec, -1
    s_nop 1
    v_lshlrev_b32 v4, 2, v1
    v_add_u32 v4, 28928, v4
    v_add_u32 v5, 65536, v4
    v_mov_b32 v30, 2176
    v_mov_b32 v28, 0
    v_mov_b32 v29, 0
    ds_write_b64 v30, v[28:29]
    s_waitcnt lgkmcnt(0)
    s_barrier
    ds_read_b32 v32, v4 offset:0
    ds_read_b32 v33, v4 offset:16384
    ds_read_b32 v34, v4 offset:32768
    ds_read_b32 v35, v4 offset:49152
    ds_read_b32 v36, v5 offset:0
    ds_read_b32 v37, v5 offset:16384
    ds_read_b32 v38, v5 offset:32768
    ds_read_b32 v39, v5 offset:49152
    s_waitcnt lgkmcnt(0)
    v_add_f32 v2, v32, v33
    v_add_f32 v2, v2, v34
    v_add_f32 v2, v2, v35
    v_add_f32 v2, v2, v36
    v_add_f32 v2, v2, v37
    v_add_f32 v2, v2, v38
    v_add_f32 v2, v2, v39
    ds_read_b32 v32, v4 offset:256
    ds_read_b32 v33, v4 offset:16640
    ds_read_b32 v34, v4 offset:33024
    ds_read_b32 v35, v4 offset:49408
    ds_read_b32 v36, v5 offset:256
    ds_read_b32 v37, v5 offset:16640
    ds_read_b32 v38, v5 offset:33024
    ds_read_b32 v39, v5 offset:49408
    s_waitcnt lgkmcnt(0)
    v_add_f32 v3, v32, v33
    v_add_f32 v3, v3, v34
    v_add_f32 v3, v3, v35
    v_add_f32 v3, v3, v36
    v_add_f32 v3, v3, v37
    v_add_f32 v3, v3, v38
    v_add_f32 v3, v3, v39
    ds_read_b32 v32, v4 offset:512
    ds_read_b32 v33, v4 offset:16896
    ds_read_b32 v34, v4 offset:33280
    ds_read_b32 v35, v4 offset:49664
    ds_read_b32 v36, v5 offset:512
    ds_read_b32 v37, v5 offset:16896
    ds_read_b32 v38, v5 offset:33280
    ds_read_b32 v39, v5 offset:49664
    s_waitcnt lgkmcnt(0)
    v_add_f32 v7, v32, v33
    v_add_f32 v7, v7, v34
    v_add_f32 v7, v7, v35
    v_add_f32 v7, v7, v36
    v_add_f32 v7, v7, v37
    v_add_f32 v7, v7, v38
    v_add_f32 v7, v7, v39
    ds_read_b32 v32, v4 offset:768
    ds_read_b32 v33, v4 offset:17152
    ds_read_b32 v34, v4 offset:33536
    ds_read_b32 v35, v4 offset:49920
    ds_read_b32 v36, v5 offset:768
    ds_read_b32 v37, v5 offset:17152
    ds_read_b32 v38, v5 offset:33536
    ds_read_b32 v39, v5 offset:49920
    s_waitcnt lgkmcnt(0)
    v_add_f32 v18, v32, v33
    v_add_f32 v18, v18, v34
    v_add_f32 v18, v18, v35
    v_add_f32 v18, v18, v36
    v_add_f32 v18, v18, v37
    v_add_f32 v18, v18, v38
    v_add_f32 v18, v18, v39
    v_mov_b32 v88, 0xff7fff00
    v_mov_b32 v89, s100
    v_mov_b32 v90, s100
    v_mov_b32 v91, s100
    v_mov_b32_sdwa v88, s100 dst_sel:BYTE_0 dst_unused:UNUSED_PRESERVE src0_sel:DWORD
    buffer_load_dwordx4 v[76:79], v22, s[36:39], s88 offen offset:0 sc1
    buffer_load_dwordx4 v[80:83], v22, s[36:39], s88 offen offset:1024 sc1
    buffer_load_dwordx4 v[84:87], v22, s[36:39], s88 offen offset:2048 sc1
    s_mov_b32 exec_hi, 0
    buffer_load_dwordx4 v[88:91], v22, s[36:39], s88 offen offset:3072 sc1
    s_mov_b32 exec_hi, -1
    buffer_load_dword v92, v23, s[36:39], s13 offen sc1
    buffer_load_dword v92, v23, s[36:39], s17 offen sc1
    buffer_load_dword v92, v23, s[36:39], s18 offen sc1
    buffer_load_dword v92, v23, s[36:39], s19 offen sc1
    buffer_load_dword v92, v24, s[36:39], s14 offen sc1
    buffer_load_dword v92, v24, s[36:39], s15 offen sc1
    buffer_load_ushort v92, v27, s[84:87], 0 offen
    v_mov_b32 v40, s100
    v_mov_b32 v41, s100
    v_mov_b32 v42, s100
    v_mov_b32 v43, s100
    s_waitcnt vmcnt(7)
    v_msad_u8 v4, v76, s100, 0
    v_msad_u8 v5, v84, s100, 0
    v_msad_u8 v4, v77, s100, v4
    v_msad_u8 v5, v85, s100, v5
    v_msad_u8 v4, v78, s100, v4
    v_msad_u8 v5, v86, s100, v5
    v_msad_u8 v4, v79, s100, v4
    v_msad_u8 v5, v87, s100, v5
    v_msad_u8 v4, v80, s100, v4
    v_msad_u8 v5, v88, s100, v5
    v_msad_u8 v4, v81, s100, v4
    v_msad_u8 v5, v89, s100, v5
    v_msad_u8 v4, v82, s100, v4
    v_msad_u8 v5, v90, s100, v5
    v_msad_u8 v4, v83, s100, v4
    v_msad_u8 v5, v91, s100, v5
    v_or_b32 v4, v4, v5
    v_cmp_ne_u32 vcc, 0, v4
    s_cbranch_vccz L_mlok_14
L_ml_13:
    s_sleep 4
    buffer_load_dwordx4 v[76:79], v22, s[36:39], s88 offen offset:0 sc1
    buffer_load_dwordx4 v[80:83], v22, s[36:39], s88 offen offset:1024 sc1
    buffer_load_dwordx4 v[84:87], v22, s[36:39], s88 offen offset:2048 sc1
    s_mov_b32 exec_hi, 0
    buffer_load_dwordx4 v[88:91], v22, s[36:39], s88 offen offset:3072 sc1
    s_mov_b32 exec_hi, -1
    s_waitcnt vmcnt(0)
    v_msad_u8 v4, v76, s100, 0
    v_msad_u8 v5, v84, s100, 0
    v_msad_u8 v4, v77, s100, v4
    v_msad_u8 v5, v85, s100, v5
    v_msad_u8 v4, v78, s100, v4
    v_msad_u8 v5, v86, s100, v5
    v_msad_u8 v4, v79, s100, v4
    v_msad_u8 v5, v87, s100, v5
    v_msad_u8 v4, v80, s100, v4
    v_msad_u8 v5, v88, s100, v5
    v_msad_u8 v4, v81, s100, v4
    v_msad_u8 v5, v89, s100, v5
    v_msad_u8 v4, v82, s100, v4
    v_msad_u8 v5, v90, s100, v5
    v_msad_u8 v4, v83, s100, v4
    v_msad_u8 v5, v91, s100, v5
    v_or_b32 v4, v4, v5
    v_cmp_ne_u32 vcc, 0, v4
    s_cbranch_vccz L_mlok_14
    s_sub_u32 s99, s99, 1
    s_cmp_gt_i32 s99, 0
    s_cbranch_scc1 L_ml_13
L_mlok_14:
    v_max3_f32 v4, v76, v80, v84
    v_max_f32 v4, v4, v88
    s_nop 1
    v_max_f32_dpp v4, v4, v4 row_ror:8 row_mask:0xf bank_mask:0xf
    v_mov_b32 v5, v4
    s_nop 1
    v_permlane16_swap_b32 v4, v5
    v_max_f32 v4, v4, v5
    v_mov_b32 v5, v4
    s_nop 1
    v_permlane32_swap_b32 v4, v5
    v_max_f32 v4, v4, v5
    v_sub_f32 v76, v76, v4
    v_sub_f32 v80, v80, v4
    v_sub_f32 v84, v84, v4
    v_sub_f32 v88, v88, v4
    v_exp_f32 v76, v76
    v_exp_f32 v80, v80
    v_exp_f32 v84, v84
    v_exp_f32 v88, v88
    v_mul_f32 v6, v76, v77
    v_fmac_f32 v6, v80, v81
    v_fmac_f32 v6, v84, v85
    v_fmac_f32 v6, v88, v89
    s_nop 1
    v_add_f32_dpp v6, v6, v6 row_ror:8 row_mask:0xf bank_mask:0xf
    v_mov_b32 v5, v6
    s_nop 1
    v_permlane16_swap_b32 v6, v5
    v_add_f32 v6, v6, v5
    v_mov_b32 v5, v6
    s_nop 1
    v_permlane32_swap_b32 v6, v5
    v_add_f32 v6, v6, v5
    v_rcp_f32 v6, v6
    s_nop 0
    v_mul_f32 v76, v76, v6
    v_mul_f32 v80, v80, v6
    v_mul_f32 v84, v84, v6
    v_mul_f32 v88, v88, v6
    s_waitcnt vmcnt(0)
L_hopA_15:
    buffer_load_dwordx4 v[28:31], v21, s[36:39], s62 offen sc1
    buffer_load_dwordx4 v[32:35], v21, s[36:39], s63 offen sc1
    buffer_load_dwordx4 v[36:39], v21, s[36:39], s89 offen sc1
    s_mov_b32 exec_hi, 0
    buffer_load_dwordx4 v[40:43], v21, s[36:39], s90 offen sc1
    s_mov_b32 exec_hi, -1
    s_waitcnt vmcnt(0)
    v_msad_u8 v4, v28, s100, 0
    v_msad_u8 v4, v32, s100, v4
    v_msad_u8 v4, v36, s100, v4
    v_msad_u8 v4, v40, s100, v4
    v_cmp_ne_u32 vcc, 0, v4
    s_cbranch_vccz L_hopAok_16
    s_sub_u32 s99, s99, 1
    s_cmp_gt_i32 s99, 0
    s_cbranch_scc1 L_hopA_15
L_hopAok_16:
    v_mul_f32 v60, v76, v28
    v_mul_f32 v61, v76, v29
    v_mul_f32 v62, v76, v30
    v_mul_f32 v63, v76, v31
    v_fmac_f32 v60, v80, v32
    v_fmac_f32 v61, v80, v33
    v_fmac_f32 v62, v80, v34
    v_fmac_f32 v63, v80, v35
    v_fmac_f32 v60, v84, v36
    v_fmac_f32 v61, v84, v37
    v_fmac_f32 v62, v84, v38
    v_fmac_f32 v63, v84, v39
    v_fmac_f32 v60, v88, v40
    v_fmac_f32 v61, v88, v41
    v_fmac_f32 v62, v88, v42
    v_fmac_f32 v63, v88, v43
    v_permlane32_swap_b32 v60, v61
    s_nop 0
    v_permlane32_swap_b32 v62, v63
    v_add_f32 v60, v60, v61
    v_add_f32 v62, v62, v63
    s_nop 1
    v_permlane16_swap_b32 v60, v62
    v_add_f32 v60, v60, v62
    s_nop 1
    v_add_f32_dpp v60, v60, v60 row_ror:8 row_mask:0xf bank_mask:0xf
    v_cvt_pk_bf16_f32 v60, v60, v60
    ds_write_b16 v12, v60
    ds_read_b128 v[8:11], v26
    v_lshl_add_u32 v4, v1, 5, s8
    s_waitcnt lgkmcnt(0)
    v_mfma_f32_16x16x32_bf16 v[32:35], v[8:11], v[96:99], 0
    v_mfma_f32_16x16x32_bf16 v[36:39], v[8:11], v[100:103], 0
    v_mfma_f32_16x16x32_bf16 v[40:43], v[8:11], v[104:107], 0
    v_mfma_f32_16x16x32_bf16 v[44:47], v[8:11], v[108:111], 0
    v_mfma_f32_16x16x32_bf16 v[48:51], v[8:11], v[112:115], 0
    v_mfma_f32_16x16x32_bf16 v[52:55], v[8:11], v[116:119], 0
    v_mfma_f32_16x16x32_bf16 v[56:59], v[8:11], v[120:123], 0
    v_mfma_f32_16x16x32_bf16 v[60:63], v[8:11], v[124:127], 0
    v_mfma_f32_16x16x32_bf16 v[64:67], v[8:11], v[128:131], 0
    v_mfma_f32_16x16x32_bf16 v[68:71], v[8:11], v[132:135], 0
    v_mfma_f32_16x16x32_bf16 v[72:75], v[8:11], v[136:139], 0
    v_mfma_f32_16x16x32_bf16 v[76:79], v[8:11], v[140:143], 0
    v_mfma_f32_16x16x32_bf16 v[80:83], v[8:11], v[144:147], 0
    v_mfma_f32_16x16x32_bf16 v[84:87], v[8:11], v[148:151], 0
    v_mfma_f32_16x16x32_bf16 v[88:91], v[8:11], v[152:155], 0
    v_mfma_f32_16x16x32_bf16 v[92:95], v[8:11], v[156:159], 0
    s_mov_b64 exec, 0xffff
    ds_write2_b32 v4, v32, v36 offset0:0 offset1:1
    ds_write2_b32 v4, v40, v44 offset0:2 offset1:3
    ds_write2_b32 v4, v48, v52 offset0:4 offset1:5
    ds_write2_b32 v4, v56, v60 offset0:6 offset1:7
    ds_write2_b32 v4, v64, v68 offset0:128 offset1:129
    ds_write2_b32 v4, v72, v76 offset0:130 offset1:131
    ds_write2_b32 v4, v80, v84 offset0:132 offset1:133
    ds_write2_b32 v4, v88, v92 offset0:134 offset1:135
    s_mov_b64 exec, -1
    v_lshrrev_b32 v4, 3, v1
    v_and_b32 v5, 7, v1
    v_lshlrev_b32 v5, 4, v5
    v_lshl_add_u32 v4, v4, 10, v5
    s_lshl_b32 s91, s3, 7
    v_add_u32 v4, s91, v4
    v_lshrrev_b32 v6, 4, v1
    v_and_b32 v29, 1, v6
    v_lshlrev_b32 v29, 3, v29
    v_lshrrev_b32 v6, 1, v6
    v_lshl_add_u32 v6, v6, 2, v29
    v_add3_u32 v6, v6, v5, s91
    s_waitcnt lgkmcnt(0)
    s_barrier
    ds_read_b128 v[28:31], v4 offset:10496
    s_waitcnt lgkmcnt(0)
    v_permlane32_swap_b32 v28, v29
    v_permlane32_swap_b32 v30, v31
    v_add_f32 v28, v28, v29
    v_add_f32 v30, v30, v31
    s_nop 1
    v_permlane16_swap_b32 v28, v30
    v_add_f32 v28, v28, v30
    s_nop 1
    v_add_f32_dpp v28, v28, v28 row_ror:8 row_mask:0xf bank_mask:0xf
    v_mov_b32_sdwa v28, s100 dst_sel:BYTE_0 dst_unused:UNUSED_PRESERVE src0_sel:DWORD
    s_cmp_eq_u32 s98, 1
    s_cbranch_scc1 L_fast_17
    buffer_store_dword v28, v6, s[36:39], s9 offen sc1
    s_branch L_stend_18
L_fast_17:
    buffer_store_dword v28, v6, s[36:39], s9 offen
L_stend_18:
    s_mul_i32 s91, s3, 16384
    s_add_u32 s91, s91, 28928
    v_lshl_add_u32 v4, v1, 4, s91
    ds_read_b128 v[44:47], v4 offset:8192
    ds_read_b128 v[48:51], v4 offset:9216
    ds_read_b128 v[52:55], v4 offset:10240
    ds_read_b128 v[56:59], v4 offset:11264
    ds_read_b128 v[60:63], v4 offset:12288
    ds_read_b128 v[64:67], v4 offset:13312
    ds_read_b128 v[68:71], v4 offset:14336
    ds_read_b128 v[72:75], v4 offset:15360
    s_waitcnt lgkmcnt(0)
    v_perm_b32 v224, v48, v44, s94
    v_perm_b32 v228, v48, v44, s95
    v_perm_b32 v225, v56, v52, s94
    v_perm_b32 v229, v56, v52, s95
    v_perm_b32 v226, v64, v60, s94
    v_perm_b32 v230, v64, v60, s95
    v_perm_b32 v227, v72, v68, s94
    v_perm_b32 v231, v72, v68, s95
    v_perm_b32 v232, v49, v45, s94
    v_perm_b32 v236, v49, v45, s95
    v_perm_b32 v233, v57, v53, s94
    v_perm_b32 v237, v57, v53, s95
    v_perm_b32 v234, v65, v61, s94
    v_perm_b32 v238, v65, v61, s95
    v_perm_b32 v235, v73, v69, s94
    v_perm_b32 v239, v73, v69, s95
    v_perm_b32 v240, v50, v46, s94
    v_perm_b32 v244, v50, v46, s95
    v_perm_b32 v241, v58, v54, s94
    v_perm_b32 v245, v58, v54, s95
    v_perm_b32 v242, v66, v62, s94
    v_perm_b32 v246, v66, v62, s95
    v_perm_b32 v243, v74, v70, s94
    v_perm_b32 v247, v74, v70, s95
    v_perm_b32 v248, v51, v47, s94
    v_perm_b32 v252, v51, v47, s95
    v_perm_b32 v249, v59, v55, s94
    v_perm_b32 v253, v59, v55, s95
    v_perm_b32 v250, v67, v63, s94
    v_perm_b32 v254, v67, v63, s95
    v_perm_b32 v251, v75, v71, s94
    v_perm_b32 v255, v75, v71, s95
L_hopB_19:
    buffer_load_dwordx4 v[28:31], v23, s[36:39], s13 offen sc1
    buffer_load_dwordx4 v[32:35], v23, s[36:39], s17 offen sc1
    buffer_load_dwordx4 v[36:39], v23, s[36:39], s18 offen sc1
    buffer_load_dwordx4 v[40:43], v23, s[36:39], s19 offen sc1
    s_waitcnt vmcnt(0)
    v_msad_u8 v4, v28, s100, 0
    v_msad_u8 v4, v32, s100, v4
    v_msad_u8 v4, v36, s100, v4
    v_msad_u8 v4, v40, s100, v4
    v_cmp_ne_u32 vcc, 0, v4
    s_cbranch_vccz L_hopBok_20
    s_sub_u32 s99, s99, 1
    s_cmp_gt_i32 s99, 0
    s_cbranch_scc1 L_hopB_19
L_hopBok_20:
    v_pk_add_f32 v[28:29], v[28:29], v[32:33]
    v_pk_add_f32 v[36:37], v[36:37], v[40:41]
    v_pk_add_f32 v[30:31], v[30:31], v[34:35]
    v_pk_add_f32 v[38:39], v[38:39], v[42:43]
    v_pk_add_f32 v[28:29], v[28:29], v[36:37]
    v_pk_add_f32 v[30:31], v[30:31], v[38:39]
    s_nop 0
    v_permlane32_swap_b32 v28, v29
    v_permlane32_swap_b32 v30, v31
    v_add_f32 v28, v28, v29
    v_add_f32 v30, v30, v31
    s_nop 1
    v_permlane16_swap_b32 v28, v30
    v_add_f32 v28, v28, v30
    v_fma_f32 v44, v16, v28, v19
    v_mul_f32 v6, v44, v17
    v_mov_b32 v4, v44
    v_mul_f32 v5, v44, v44
    v_cvt_pk_bf16_f32 v6, v6, v6
    ds_write_b16 v13, v6 offset:64
    ds_read_b128 v[8:11], v25 offset:64
    ds_write_b32 v14, v44 offset:22784
    v_permlane32_swap_b32 v4, v5
    v_add_f32 v4, v4, v5
    v_mov_b32 v5, v4
    s_nop 1
    v_permlane16_swap_b32 v4, v5
    v_add_f32 v4, v4, v5
    s_waitcnt lgkmcnt(1)
    v_mfma_f32_16x16x32_bf16 v[32:35], v[8:11], v[160:163], 0
    v_mfma_f32_16x16x32_bf16 v[36:39], v[8:11], v[164:167], 0
    v_add_f32_dpp v4, v4, v4 row_ror:1 row_mask:0xf bank_mask:0xf
    v_mfma_f32_16x16x32_bf16 v[40:43], v[8:11], v[168:171], 0
    v_mfma_f32_16x16x32_bf16 v[44:47], v[8:11], v[172:175], 0
    v_add_f32_dpp v4, v4, v4 row_ror:2 row_mask:0xf bank_mask:0xf
    v_mfma_f32_16x16x32_bf16 v[48:51], v[8:11], v[176:179], 0
    v_mfma_f32_16x16x32_bf16 v[52:55], v[8:11], v[180:183], 0
    v_add_f32_dpp v4, v4, v4 row_ror:4 row_mask:0xf bank_mask:0xf
    v_mfma_f32_16x16x32_bf16 v[56:59], v[8:11], v[184:187], 0
    v_mfma_f32_16x16x32_bf16 v[60:63], v[8:11], v[188:191], 0
    v_add_f32_dpp v4, v4, v4 row_ror:8 row_mask:0xf bank_mask:0xf
    v_mfma_f32_16x16x32_bf16 v[64:67], v[8:11], v[192:195], 0
    v_mfma_f32_16x16x32_bf16 v[68:71], v[8:11], v[196:199], 0
    v_mfma_f32_16x16x32_bf16 v[72:75], v[8:11], v[200:203], 0
    v_mfma_f32_16x16x32_bf16 v[76:79], v[8:11], v[204:207], 0
    v_mfma_f32_16x16x32_bf16 v[80:83], v[8:11], v[208:211], 0
    v_mfma_f32_16x16x32_bf16 v[84:87], v[8:11], v[212:215], 0
    v_mfma_f32_16x16x32_bf16 v[88:91], v[8:11], v[216:219], 0
    v_mfma_f32_16x16x32_bf16 v[92:95], v[8:11], v[220:223], 0
    v_lshrrev_b32 v5, 5, v1
    v_lshlrev_b32 v5, 2, v5
    s_mov_b32 exec_lo, 1
    s_mov_b32 exec_hi, 1
    ds_add_f32 v5, v4 offset:2176
    s_mov_b64 exec, -1
    v_lshl_add_u32 v4, v1, 5, s11
    v_add_f32_dpp v32, v33, v32 row_shl:8 row_mask:0xf bank_mask:0xf
    v_add_f32_dpp v33, v37, v36 row_shl:8 row_mask:0xf bank_mask:0xf
    v_add_f32_dpp v34, v41, v40 row_shl:8 row_mask:0xf bank_mask:0xf
    v_add_f32_dpp v35, v45, v44 row_shl:8 row_mask:0xf bank_mask:0xf
    v_add_f32_dpp v36, v49, v48 row_shl:8 row_mask:0xf bank_mask:0xf
    v_add_f32_dpp v37, v53, v52 row_shl:8 row_mask:0xf bank_mask:0xf
    v_add_f32_dpp v38, v57, v56 row_shl:8 row_mask:0xf bank_mask:0xf
    v_add_f32_dpp v39, v61, v60 row_shl:8 row_mask:0xf bank_mask:0xf
    v_add_f32_dpp v64, v65, v64 row_shl:8 row_mask:0xf bank_mask:0xf
    v_add_f32_dpp v65, v69, v68 row_shl:8 row_mask:0xf bank_mask:0xf
    v_add_f32_dpp v66, v73, v72 row_shl:8 row_mask:0xf bank_mask:0xf
    v_add_f32_dpp v67, v77, v76 row_shl:8 row_mask:0xf bank_mask:0xf
    v_add_f32_dpp v68, v81, v80 row_shl:8 row_mask:0xf bank_mask:0xf
    v_add_f32_dpp v69, v85, v84 row_shl:8 row_mask:0xf bank_mask:0xf
    v_add_f32_dpp v70, v89, v88 row_shl:8 row_mask:0xf bank_mask:0xf
    v_add_f32_dpp v71, v93, v92 row_shl:8 row_mask:0xf bank_mask:0xf
    s_mov_b64 exec, 0xff
    ds_write_b128 v4, v[32:35]
    ds_write_b128 v4, v[36:39] offset:16
    ds_write_b128 v4, v[64:67] offset:256
    ds_write_b128 v4, v[68:71] offset:272
    s_mov_b64 exec, -1
    v_lshlrev_b32 v4, 2, v1
    v_add_u32 v4, 18688, v4
    v_mov_b32 v6, 0
    s_waitcnt lgkmcnt(0)
    s_barrier
    ds_read_b64 v[28:29], v6 offset:2176
    ds_read2st64_b32 v[48:49], v4 offset0:0 offset1:1
    ds_read2st64_b32 v[50:51], v4 offset0:2 offset1:3
    ds_read2st64_b32 v[52:53], v4 offset0:4 offset1:5
    ds_read2st64_b32 v[54:55], v4 offset0:6 offset1:7
    ds_read2st64_b32 v[56:57], v4 offset0:8 offset1:9
    ds_read2st64_b32 v[58:59], v4 offset0:10 offset1:11
    ds_read2st64_b32 v[60:61], v4 offset0:12 offset1:13
    ds_read2st64_b32 v[62:63], v4 offset0:14 offset1:15
    ds_read_b32 v44, v15 offset:22784
    v_lshlrev_b32 v5, 1, v1
    v_add_u32 v5, s16, v5
    s_waitcnt lgkmcnt(9)
    v_mul_f32 v4, 0x3b000000, v28
    v_mul_f32 v6, 0x3b000000, v29
    v_fma_f32 v6, -v4, v4, v6
    v_add_f32 v6, 0x3727c5ac, v6
    v_rsq_f32 v6, v6
    s_waitcnt lgkmcnt(1)
    v_pk_add_f32 v[48:49], v[48:49], v[50:51]
    v_pk_add_f32 v[52:53], v[52:53], v[54:55]
    v_pk_add_f32 v[56:57], v[56:57], v[58:59]
    v_pk_add_f32 v[60:61], v[60:61], v[62:63]
    v_pk_add_f32 v[48:49], v[48:49], v[52:53]
    v_pk_add_f32 v[56:57], v[56:57], v[60:61]
    v_pk_add_f32 v[48:49], v[48:49], v[56:57]
    v_fma_f32 v48, -v4, v2, v48
    v_fma_f32 v49, -v4, v7, v49
    v_fma_f32 v48, v48, v6, v3
    v_fma_f32 v49, v49, v6, v18
    v_mul_f32 v4, 0xbfb8aa3b, v48
    v_exp_f32 v4, v4
    v_mul_f32 v48, v48, v49
    v_add_f32 v4, 1.0, v4
    v_rcp_f32 v4, v4
    s_nop 0
    v_mul_f32 v4, v48, v4
    v_cvt_pk_bf16_f32 v4, v4, v4
    ds_write_b16 v5, v4 offset:320
    ds_read_b128 v[8:11], v25 offset:320
    v_lshrrev_b32 v4, 3, v1
    v_and_b32 v5, 7, v1
    v_lshlrev_b32 v5, 5, v5
    v_lshl_add_u32 v4, v4, 4, v5
    s_waitcnt lgkmcnt(0)
    v_mfma_f32_16x16x32_bf16 v[64:67], v[8:11], v[224:227], 0
    v_mfma_f32_16x16x32_bf16 v[68:71], v[8:11], v[228:231], 0
    v_mfma_f32_16x16x32_bf16 v[72:75], v[8:11], v[232:235], 0
    v_mfma_f32_16x16x32_bf16 v[76:79], v[8:11], v[236:239], 0
    v_mfma_f32_16x16x32_bf16 v[80:83], v[8:11], v[240:243], 0
    v_mfma_f32_16x16x32_bf16 v[84:87], v[8:11], v[244:247], 0
    v_mfma_f32_16x16x32_bf16 v[88:91], v[8:11], v[248:251], 0
    v_mfma_f32_16x16x32_bf16 v[92:95], v[8:11], v[252:255], 0
    s_nop 0
    v_add_f32_dpp v64, v65, v64 row_shl:8 row_mask:0xf bank_mask:0xf
    v_add_f32_dpp v65, v69, v68 row_shl:8 row_mask:0xf bank_mask:0xf
    v_add_f32_dpp v66, v73, v72 row_shl:8 row_mask:0xf bank_mask:0xf
    v_add_f32_dpp v67, v77, v76 row_shl:8 row_mask:0xf bank_mask:0xf
    v_add_f32_dpp v68, v81, v80 row_shl:8 row_mask:0xf bank_mask:0xf
    v_add_f32_dpp v69, v85, v84 row_shl:8 row_mask:0xf bank_mask:0xf
    v_add_f32_dpp v70, v89, v88 row_shl:8 row_mask:0xf bank_mask:0xf
    v_add_f32_dpp v71, v93, v92 row_shl:8 row_mask:0xf bank_mask:0xf
    v_mov_b32_dpp v64, v68 row_shr:8 row_mask:0xf bank_mask:0xc
    v_mov_b32_dpp v65, v69 row_shr:8 row_mask:0xf bank_mask:0xc
    v_mov_b32_dpp v66, v70 row_shr:8 row_mask:0xf bank_mask:0xc
    v_mov_b32_dpp v67, v71 row_shr:8 row_mask:0xf bank_mask:0xc
    v_mov_b32_sdwa v64, s100 dst_sel:BYTE_0 dst_unused:UNUSED_PRESERVE src0_sel:DWORD
    v_mov_b32_sdwa v65, s100 dst_sel:BYTE_0 dst_unused:UNUSED_PRESERVE src0_sel:DWORD
    v_mov_b32_sdwa v66, s100 dst_sel:BYTE_0 dst_unused:UNUSED_PRESERVE src0_sel:DWORD
    v_mov_b32_sdwa v67, s100 dst_sel:BYTE_0 dst_unused:UNUSED_PRESERVE src0_sel:DWORD
    s_mov_b64 exec, 0xffff
    s_cmp_eq_u32 s98, 1
    s_cbranch_scc1 L_fast_21
    buffer_store_dwordx4 v[64:67], v4, s[36:39], s12 offen sc1
    s_branch L_stend_22
L_fast_21:
    buffer_store_dwordx4 v[64:67], v4, s[36:39], s12 offen
L_stend_22:
    s_mov_b64 exec, -1
L_final:
    s_waitcnt lgkmcnt(0)
    s_cmp_lg_u32 s3, 0
    s_cbranch_scc1 L_svc_end_23
    v_mov_b32 v32, s100
    v_mov_b32 v33, s100
    v_mov_b32 v34, s100
    v_mov_b32 v35, s100
L_hopC_24:
    buffer_load_dwordx4 v[28:31], v24, s[36:39], s14 offen sc1
    s_mov_b32 exec_hi, 0xffff
    buffer_load_dwordx4 v[32:35], v24, s[36:39], s15 offen sc1
    s_mov_b32 exec_hi, -1
    s_waitcnt vmcnt(0)
    v_msad_u8 v4, v28, s100, 0
    v_msad_u8 v4, v32, s100, v4
    v_cmp_ne_u32 vcc, 0, v4
    s_cbranch_vccz L_hopCok_25
    s_sub_u32 s99, s99, 1
    s_cmp_gt_i32 s99, 0
    s_cbranch_scc1 L_hopC_24
L_hopCok_25:
    v_add_f32 v28, v28, v32
    v_add_f32 v29, v29, v33
    v_add_f32 v30, v30, v34
    v_add_f32 v31, v31, v35
    v_permlane32_swap_b32 v28, v29
    s_nop 0
    v_permlane32_swap_b32 v30, v31
    v_add_f32 v28, v28, v29
    v_add_f32 v30, v30, v31
    s_nop 1
    v_permlane16_swap_b32 v28, v30
    v_add_f32 v28, v28, v30
    s_nop 1
    v_add_f32_dpp v28, v28, v28 row_ror:4 row_mask:0xf bank_mask:0xf
    s_nop 1
    v_add_f32_dpp v28, v28, v28 row_ror:8 row_mask:0xf bank_mask:0xf
    v_fma_f32 v28, v20, v28, v44
    v_cvt_pk_bf16_f32 v28, v28, v28
    buffer_store_short v28, v27, s[84:87], 0 offen
L_svc_end_23:
    s_endpgm
L_exit:
    s_endpgm
L_code_end:
.section .rodata,"a"
.p2align 6
.amdhsa_kernel adaLN_cond__gqa_block_cached__swiglu_ffn__decode_kernel
  .amdhsa_next_free_vgpr 256
  .amdhsa_next_free_sgpr 102
  .amdhsa_accum_offset 256
  .amdhsa_group_segment_fixed_size 0
  .amdhsa_kernarg_size 112
  .amdhsa_user_sgpr_count 2
  .amdhsa_user_sgpr_kernarg_segment_ptr 1
  .amdhsa_system_sgpr_workgroup_id_x 1
.end_amdhsa_kernel
```
